```python
import torch

def _softmax(x, axis=-1):
    return torch.softmax(x, dim=axis)
def _gelu(x):
    return torch.nn.functional.gelu(x, approximate="tanh")
def _silu(x):
    return torch.nn.functional.silu(x)
def _sigmoid(x):
    return torch.sigmoid(x)
def _layernorm(x, axis=-1, eps=1e-5):
    m = x.mean(dim=axis, keepdim=True)
    v = x.var(dim=axis, keepdim=True, unbiased=False)
    return (x - m) / torch.sqrt(v + eps)
def _scatter_add(tgt, idx, src, axis=0):
    return tgt.clone().index_add_(axis, idx, src)
def _segment_sum(src, seg, n):
    out = torch.zeros((n,) + src.shape[1:], dtype=src.dtype)
    return out.index_add_(0, seg, src)
def _pad(x, pw):
    flat = tuple(v for pair in reversed(pw) for v in pair)
    return torch.nn.functional.pad(x, flat)

kernel_name = 'interleave_layers__sliding_block_cached__mixer_channel_mlp__decode'

def setup_inputs():

    _w = (lambda a: (lambda t: t.to(torch.bfloat16) if t.is_floating_point() else t)(torch.as_tensor(a)))
    def _A_setup():
        B, Sq, D = 1, 1, 448
        Hq, Hkv, Sk, Dh = 16, 8, 65536, 256
        assert Hq % Hkv == 0, (Hq, Hkv)
        return {
            "x": _w((lambda *s: torch.randn(*s, dtype=torch.bfloat16) * 0.05)(B, Sq, D)),
            "k_cache": _w((lambda *s: torch.randn(*s, dtype=torch.bfloat16) * 3.2)(B, Hkv, Sk, Dh)),
            "v_cache": _w((lambda *s: torch.randn(*s, dtype=torch.bfloat16) * 3.2)(B, Hkv, Sk, Dh)),
            "wq": _w((lambda *s: torch.randn(*s, dtype=torch.bfloat16) * 3.2)(D, Hq * Dh) * (D ** -0.5)),
            "wo": _w((lambda *s: torch.randn(*s, dtype=torch.bfloat16) * 3.2)(Hq * Dh, D) * ((Hq * Dh) ** -0.5)),
        }
    _A_in = _A_setup()

    def _B_setup():
        B, S, D, F = 1, 1, 448, 1792
        return {
            "x": _w((lambda *s: torch.randn(*s, dtype=torch.bfloat16) * 0.05)(B, S, D)),
            "w1": _w((lambda *s: torch.randn(*s, dtype=torch.bfloat16) * 3.2)(D, F) * (D ** -0.5)),
            "b1": _w((lambda *s: torch.randn(*s, dtype=torch.bfloat16) * 3.2)(F)),
            "w2": _w((lambda *s: torch.randn(*s, dtype=torch.bfloat16) * 3.2)(F, D) * (F ** -0.5)),
            "b2": _w((lambda *s: torch.randn(*s, dtype=torch.bfloat16) * 3.2)(D)),
        }
    _B_in = _B_setup()

    return {
        "A_x": _A_in["x"],
        "A_k_cache": _A_in["k_cache"],
        "A_v_cache": _A_in["v_cache"],
        "A_wq": _A_in["wq"],
        "A_wo": _A_in["wo"],
        "B_x": _B_in["x"],
        "B_w1": _B_in["w1"],
        "B_b1": _B_in["b1"],
        "B_w2": _B_in["w2"],
        "B_b2": _B_in["b2"],
    }

def reference(A_x, A_k_cache, A_v_cache, A_wq, A_wo, B_x, B_w1, B_b1, B_w2, B_b2):
    def _A_ref(x, k_cache, v_cache, wq, wo):
        B, Sq, D = x.shape
        Hq, Dh = 16, 256
        Hkv, Sk = k_cache.shape[1], k_cache.shape[2]
        W = min(4096, max(256, Sk // 4))
        rep = Hq // Hkv
        q = (lambda x, *d: x.permute(*d))((x @ wq).reshape(B, Sq, Hq, Dh), 0, 2, 1, 3)
        k = (lambda x, n, axis: torch.repeat_interleave(x, n, dim=axis))(k_cache[:, :, Sk - W:, :], rep, axis=1)
        v = (lambda x, n, axis: torch.repeat_interleave(x, n, dim=axis))(v_cache[:, :, Sk - W:, :], rep, axis=1)
        scores = torch.einsum("bhqd,bhkd->bhqk", q, k) * (Dh ** -0.5)
        p = _softmax(scores, axis=-1)
        o = torch.einsum("bhqk,bhkd->bhqd", p, v)
        return (lambda x, *d: x.permute(*d))(o, 0, 2, 1, 3).reshape(B, Sq, Hq * Dh) @ wo

    def _B_ref(x, w1, b1, w2, b2):
        y = _layernorm(x, axis=-1)
        h = _gelu(torch.einsum("bsd,df->bsf", y, w1) + b1)
        return torch.einsum("bsf,fd->bsd", h, w2) + b2

    x = A_x
    x = x + _A_ref(_layernorm(x, axis=-1), A_k_cache, A_v_cache, A_wq, A_wo)
    x = x + _B_ref(_layernorm(x, axis=-1), B_w1, B_b1, B_w2, B_b2)
    x = x + _A_ref(_layernorm(x, axis=-1), A_k_cache, A_v_cache, A_wq, A_wo)
    x = x + _B_ref(_layernorm(x, axis=-1), B_w1, B_b1, B_w2, B_b2)
    return x
```

```asm
; @launch grid=(256,1,1) block=(512,1,1) lds=102784
.amdgcn_target "amdgcn-amd-amdhsa--gfx950"
.text
.globl interleave_layers__sliding_block_cached__mixer_channel_mlp__decode_kernel
.p2align 8
.type interleave_layers__sliding_block_cached__mixer_channel_mlp__decode_kernel,@function
interleave_layers__sliding_block_cached__mixer_channel_mlp__decode_kernel:
    s_cmp_ge_u32 s2, 256
    s_cbranch_scc1 L_end
    s_load_dwordx16 s[4:19], s[0:1], 0
    s_load_dwordx8 s[20:27], s[0:1], 64
    s_load_dwordx2 s[28:29], s[0:1], 96
    v_and_b32 v1, 63, v0
    v_lshrrev_b32 v2, 6, v0
    s_and_b32 s31, s2, 7
    v_readfirstlane_b32 s30, v2
    s_lshr_b32 s3, s2, 3
    s_cmp_ge_u32 s3, 28
    s_cselect_b32 s52, 28, 0
    s_sub_u32 s101, s3, s52
    s_cmp_ge_u32 s101, 14
    s_cselect_b32 s52, 14, 0
    s_sub_u32 s100, s101, s52
    s_mov_b32 s82, 0x05040100
    s_mov_b32 s83, 0x07060302
    s_mov_b32 s81, 0x8000
    s_waitcnt lgkmcnt(0)
    s_mov_b32 s32, s28
    s_and_b32 s33, s29, 0xffff
    s_mov_b32 s34, 0x308000
    s_mov_b32 s35, 0x00020000
    s_cmp_ge_u32 s30, 4
    s_cbranch_scc1 L_G
    s_lshl_b32 s52, s31, 25
    s_lshl_b32 s53, s3, 16
    s_add_u32 s52, s52, s53
    s_lshl_b32 s53, s30, 14
    s_add_u32 s52, s52, s53
    s_add_u32 s52, s52, 31457280
    s_add_u32 s36, s6, s52
    s_addc_u32 s37, s7, 0
    s_and_b32 s37, s37, 0xffff
    s_mov_b32 s38, 0x4000
    s_mov_b32 s39, 0x00020000
    s_add_u32 s40, s8, s52
    s_addc_u32 s41, s9, 0
    s_and_b32 s41, s41, 0xffff
    s_mov_b32 s42, 0x4000
    s_mov_b32 s43, 0x00020000
    v_and_b32 v12, 15, v1
    v_lshrrev_b32 v13, 4, v1
    v_lshlrev_b32 v2, 9, v12
    v_lshl_add_u32 v2, v13, 4, v2
    v_add_u32 v3, 8192, v2
    v_lshlrev_b32 v4, 4, v1
    s_mov_b32 s57, 4096
    s_mov_b32 s58, 8192
    s_mov_b32 s59, 12288
    s_barrier
    buffer_load_dwordx4 v[64:67], v2, s[36:39], 0 offen offset:0 nt
    buffer_load_dwordx4 v[68:71], v2, s[36:39], 0 offen offset:64 nt
    buffer_load_dwordx4 v[72:75], v2, s[36:39], 0 offen offset:128 nt
    buffer_load_dwordx4 v[76:79], v2, s[36:39], 0 offen offset:192 nt
    buffer_load_dwordx4 v[80:83], v2, s[36:39], 0 offen offset:256 nt
    buffer_load_dwordx4 v[84:87], v2, s[36:39], 0 offen offset:320 nt
    buffer_load_dwordx4 v[88:91], v2, s[36:39], 0 offen offset:384 nt
    buffer_load_dwordx4 v[92:95], v2, s[36:39], 0 offen offset:448 nt
    buffer_load_dwordx4 v[96:99], v3, s[36:39], 0 offen offset:0 nt
    buffer_load_dwordx4 v[100:103], v3, s[36:39], 0 offen offset:64 nt
    buffer_load_dwordx4 v[104:107], v3, s[36:39], 0 offen offset:128 nt
    buffer_load_dwordx4 v[108:111], v3, s[36:39], 0 offen offset:192 nt
    buffer_load_dwordx4 v[112:115], v3, s[36:39], 0 offen offset:256 nt
    buffer_load_dwordx4 v[116:119], v3, s[36:39], 0 offen offset:320 nt
    buffer_load_dwordx4 v[120:123], v3, s[36:39], 0 offen offset:384 nt
    buffer_load_dwordx4 v[124:127], v3, s[36:39], 0 offen offset:448 nt
    v_lshrrev_b32 v14, 5, v1
    v_mul_u32_u24 v14, 544, v14
    v_and_b32 v15, 31, v1
    v_lshl_add_u32 v5, v15, 4, v14
    s_mul_i32 s52, s30, 17408
    s_add_u32 s52, s52, 33152
    v_add_u32 v5, s52, v5
    v_lshrrev_b32 v14, 2, v12
    v_lshl_add_u32 v14, v13, 3, v14
    v_mul_u32_u24 v14, 544, v14
    v_and_b32 v15, 3, v12
    v_lshl_add_u32 v6, v15, 3, v14
    s_lshl_b32 s52, s30, 7
    s_add_u32 s52, s52, 33152
    v_add_u32 v6, s52, v6
    v_min_u32 v14, 2, v12
    v_lshlrev_b32 v15, 9, v14
    v_lshl_add_u32 v7, v13, 4, v15
    v_lshlrev_b32 v15, 8, v14
    v_lshl_add_u32 v8, v13, 4, v15
    s_lshl_b32 s52, s30, 6
    v_lshl_add_u32 v9, v1, 1, s52
    v_lshlrev_b32 v10, 2, v1
    v_mov_b32 v11, 0
    s_lshl_b32 s52, s30, 4
    v_mov_b32 v24, s52
    s_lshl_b32 s87, s31, 16
    s_lshl_b32 s53, s30, 13
    s_add_u32 s87, s87, s53
    s_lshl_b32 s53, s3, 6
    s_add_u32 s87, s87, s53
    s_lshl_b32 s92, s31, 9
    s_lshl_b32 s53, s3, 3
    s_add_u32 s92, s92, s53
    s_add_u32 s92, s92, 0x160000
    buffer_load_dwordx4 v[128:131], v4, s[40:43], 0 offen offset:0 nt
    buffer_load_dwordx4 v[132:135], v4, s[40:43], 0 offen offset:1024 nt
    buffer_load_dwordx4 v[136:139], v4, s[40:43], 0 offen offset:2048 nt
    buffer_load_dwordx4 v[140:143], v4, s[40:43], 0 offen offset:3072 nt
    buffer_load_dwordx4 v[144:147], v4, s[40:43], s57 offen offset:0 nt
    buffer_load_dwordx4 v[148:151], v4, s[40:43], s57 offen offset:1024 nt
    buffer_load_dwordx4 v[152:155], v4, s[40:43], s57 offen offset:2048 nt
    buffer_load_dwordx4 v[156:159], v4, s[40:43], s57 offen offset:3072 nt
    buffer_load_dwordx4 v[160:163], v4, s[40:43], s58 offen offset:0 nt
    buffer_load_dwordx4 v[164:167], v4, s[40:43], s58 offen offset:1024 nt
    buffer_load_dwordx4 v[168:171], v4, s[40:43], s58 offen offset:2048 nt
    buffer_load_dwordx4 v[172:175], v4, s[40:43], s58 offen offset:3072 nt
    buffer_load_dwordx4 v[176:179], v4, s[40:43], s59 offen offset:0 nt
    buffer_load_dwordx4 v[180:183], v4, s[40:43], s59 offen offset:1024 nt
    buffer_load_dwordx4 v[184:187], v4, s[40:43], s59 offen offset:2048 nt
    buffer_load_dwordx4 v[188:191], v4, s[40:43], s59 offen offset:3072 nt
    s_waitcnt vmcnt(15)
    ds_write_b128 v5, v[128:131] offset:0
    s_waitcnt vmcnt(14)
    ds_write_b128 v5, v[132:135] offset:1088
    s_waitcnt vmcnt(13)
    ds_write_b128 v5, v[136:139] offset:2176
    s_waitcnt vmcnt(12)
    ds_write_b128 v5, v[140:143] offset:3264
    s_waitcnt vmcnt(11)
    ds_write_b128 v5, v[144:147] offset:4352
    s_waitcnt vmcnt(10)
    ds_write_b128 v5, v[148:151] offset:5440
    s_waitcnt vmcnt(9)
    ds_write_b128 v5, v[152:155] offset:6528
    s_waitcnt vmcnt(8)
    ds_write_b128 v5, v[156:159] offset:7616
    s_waitcnt vmcnt(7)
    ds_write_b128 v5, v[160:163] offset:8704
    s_waitcnt vmcnt(6)
    ds_write_b128 v5, v[164:167] offset:9792
    s_waitcnt vmcnt(5)
    ds_write_b128 v5, v[168:171] offset:10880
    s_waitcnt vmcnt(4)
    ds_write_b128 v5, v[172:175] offset:11968
    s_waitcnt vmcnt(3)
    ds_write_b128 v5, v[176:179] offset:13056
    s_waitcnt vmcnt(2)
    ds_write_b128 v5, v[180:183] offset:14144
    s_waitcnt vmcnt(1)
    ds_write_b128 v5, v[184:187] offset:15232
    s_waitcnt vmcnt(0)
    ds_write_b128 v5, v[188:191] offset:16320
    v_mov_b32 v12, 1
    s_waitcnt lgkmcnt(0)
    s_mov_b32 exec_lo, 0x1
    s_mov_b32 exec_hi, 0
    ds_add_u32 v11, v12 offset:2368
    s_mov_b64 exec, -1
L_Aspin:
    ds_read_b32 v12, v11 offset:2368
    s_waitcnt lgkmcnt(0)
    v_cmp_gt_u32 vcc, 4, v12
    s_cbranch_vccnz L_Aspin
    ds_read_b64_tr_b16 v[128:129], v6 offset:0
    ds_read_b64_tr_b16 v[130:131], v6 offset:2176
    ds_read_b64_tr_b16 v[132:133], v6 offset:32
    ds_read_b64_tr_b16 v[134:135], v6 offset:2208
    ds_read_b64_tr_b16 v[136:137], v6 offset:64
    ds_read_b64_tr_b16 v[138:139], v6 offset:2240
    ds_read_b64_tr_b16 v[140:141], v6 offset:96
    ds_read_b64_tr_b16 v[142:143], v6 offset:2272
    ds_read_b64_tr_b16 v[144:145], v6 offset:17408
    ds_read_b64_tr_b16 v[146:147], v6 offset:19584
    ds_read_b64_tr_b16 v[148:149], v6 offset:17440
    ds_read_b64_tr_b16 v[150:151], v6 offset:19616
    ds_read_b64_tr_b16 v[152:153], v6 offset:17472
    ds_read_b64_tr_b16 v[154:155], v6 offset:19648
    ds_read_b64_tr_b16 v[156:157], v6 offset:17504
    ds_read_b64_tr_b16 v[158:159], v6 offset:19680
    ds_read_b64_tr_b16 v[160:161], v6 offset:34816
    ds_read_b64_tr_b16 v[162:163], v6 offset:36992
    ds_read_b64_tr_b16 v[164:165], v6 offset:34848
    ds_read_b64_tr_b16 v[166:167], v6 offset:37024
    ds_read_b64_tr_b16 v[168:169], v6 offset:34880
    ds_read_b64_tr_b16 v[170:171], v6 offset:37056
    ds_read_b64_tr_b16 v[172:173], v6 offset:34912
    ds_read_b64_tr_b16 v[174:175], v6 offset:37088
    ds_read_b64_tr_b16 v[176:177], v6 offset:52224
    ds_read_b64_tr_b16 v[178:179], v6 offset:54400
    ds_read_b64_tr_b16 v[180:181], v6 offset:52256
    ds_read_b64_tr_b16 v[182:183], v6 offset:54432
    ds_read_b64_tr_b16 v[184:185], v6 offset:52288
    ds_read_b64_tr_b16 v[186:187], v6 offset:54464
    ds_read_b64_tr_b16 v[188:189], v6 offset:52320
    ds_read_b64_tr_b16 v[190:191], v6 offset:54496
    s_waitcnt lgkmcnt(0)
L_Aloop:
    s_barrier
    ds_read_b128 v[192:195], v7 offset:0
    ds_read_b128 v[196:199], v7 offset:64
    ds_read_b128 v[200:203], v7 offset:128
    ds_read_b128 v[204:207], v7 offset:192
    ds_read_b128 v[208:211], v7 offset:256
    ds_read_b128 v[212:215], v7 offset:320
    ds_read_b128 v[216:219], v7 offset:384
    ds_read_b128 v[220:223], v7 offset:448
    s_waitcnt vmcnt(16)
    s_waitcnt lgkmcnt(7)
    v_mfma_f32_16x16x32_bf16 v[16:19], v[192:195], v[64:67], 0
    v_mfma_f32_16x16x32_bf16 v[20:23], v[192:195], v[96:99], 0
    s_waitcnt lgkmcnt(6)
    v_mfma_f32_16x16x32_bf16 v[16:19], v[196:199], v[68:71], v[16:19]
    v_mfma_f32_16x16x32_bf16 v[20:23], v[196:199], v[100:103], v[20:23]
    s_waitcnt lgkmcnt(5)
    v_mfma_f32_16x16x32_bf16 v[16:19], v[200:203], v[72:75], v[16:19]
    v_mfma_f32_16x16x32_bf16 v[20:23], v[200:203], v[104:107], v[20:23]
    s_waitcnt lgkmcnt(4)
    v_mfma_f32_16x16x32_bf16 v[16:19], v[204:207], v[76:79], v[16:19]
    v_mfma_f32_16x16x32_bf16 v[20:23], v[204:207], v[108:111], v[20:23]
    s_waitcnt lgkmcnt(3)
    v_mfma_f32_16x16x32_bf16 v[16:19], v[208:211], v[80:83], v[16:19]
    v_mfma_f32_16x16x32_bf16 v[20:23], v[208:211], v[112:115], v[20:23]
    s_waitcnt lgkmcnt(2)
    v_mfma_f32_16x16x32_bf16 v[16:19], v[212:215], v[84:87], v[16:19]
    v_mfma_f32_16x16x32_bf16 v[20:23], v[212:215], v[116:119], v[20:23]
    s_waitcnt lgkmcnt(1)
    v_mfma_f32_16x16x32_bf16 v[16:19], v[216:219], v[88:91], v[16:19]
    v_mfma_f32_16x16x32_bf16 v[20:23], v[216:219], v[120:123], v[20:23]
    s_waitcnt lgkmcnt(0)
    v_mfma_f32_16x16x32_bf16 v[16:19], v[220:223], v[92:95], v[16:19]
    v_mfma_f32_16x16x32_bf16 v[20:23], v[220:223], v[124:127], v[20:23]
    s_add_u32 s52, s87, s81
    s_add_u32 s53, s52, 4096
    s_add_u32 s54, s52, 32768
    s_add_u32 s55, s52, 36864
    s_add_u32 s56, s92, s81
    s_nop 5
    v_cvt_pk_bf16_f32 v48, v16, v17
    v_cvt_pk_bf16_f32 v49, v20, v21
    v_lshlrev_b32 v50, 16, v48
    v_and_b32 v51, 0xffff0000, v48
    v_lshlrev_b32 v52, 16, v49
    v_and_b32 v53, 0xffff0000, v49
    v_max_f32 v54, v50, v52
    v_max_f32 v55, v51, v53
    s_nop 1
    v_max_f32_dpp v54, v54, v54 row_ror:8 row_mask:0xf bank_mask:0xf
    v_max_f32_dpp v55, v55, v55 row_ror:8 row_mask:0xf bank_mask:0xf
    s_nop 0
    v_max_f32_dpp v54, v54, v54 row_ror:4 row_mask:0xf bank_mask:0xf
    v_max_f32_dpp v55, v55, v55 row_ror:4 row_mask:0xf bank_mask:0xf
    s_nop 0
    v_max_f32_dpp v54, v54, v54 row_ror:2 row_mask:0xf bank_mask:0xf
    v_max_f32_dpp v55, v55, v55 row_ror:2 row_mask:0xf bank_mask:0xf
    s_nop 0
    v_max_f32_dpp v54, v54, v54 row_ror:1 row_mask:0xf bank_mask:0xf
    v_max_f32_dpp v55, v55, v55 row_ror:1 row_mask:0xf bank_mask:0xf
    s_nop 0
    v_mov_b32 v56, 0x3db8aa3b
    v_sub_f32 v50, v50, v54
    v_sub_f32 v52, v52, v54
    v_sub_f32 v51, v51, v55
    v_sub_f32 v53, v53, v55
    v_mul_f32 v50, v56, v50
    v_mul_f32 v51, v56, v51
    v_mul_f32 v52, v56, v52
    v_mul_f32 v53, v56, v53
    v_exp_f32 v50, v50
    v_exp_f32 v51, v51
    v_exp_f32 v52, v52
    v_exp_f32 v53, v53
    v_mul_f32 v56, 0x3d800000, v54
    v_mul_f32 v58, 0x3d800000, v55
    v_add_f32 v57, v50, v52
    v_add_f32 v59, v51, v53
    v_cvt_pk_bf16_f32 v48, v50, v51
    v_cvt_pk_bf16_f32 v49, v52, v53
    s_mov_b32 exec_lo, 0xffff
    s_mov_b32 exec_hi, 0
    ds_write_b16 v9, v48 offset:1536
    ds_write_b16_d16_hi v9, v48 offset:1792
    ds_write_b16 v9, v49 offset:1568
    ds_write_b16_d16_hi v9, v49 offset:1824
    s_mov_b64 exec, -1
    v_add_f32_dpp v57, v57, v57 row_ror:8 row_mask:0xf bank_mask:0xf
    v_add_f32_dpp v59, v59, v59 row_ror:8 row_mask:0xf bank_mask:0xf
    s_nop 0
    v_add_f32_dpp v57, v57, v57 row_ror:4 row_mask:0xf bank_mask:0xf
    v_add_f32_dpp v59, v59, v59 row_ror:4 row_mask:0xf bank_mask:0xf
    s_nop 0
    v_add_f32_dpp v57, v57, v57 row_ror:2 row_mask:0xf bank_mask:0xf
    v_add_f32_dpp v59, v59, v59 row_ror:2 row_mask:0xf bank_mask:0xf
    s_nop 0
    v_add_f32_dpp v57, v57, v57 row_ror:1 row_mask:0xf bank_mask:0xf
    v_add_f32_dpp v59, v59, v59 row_ror:1 row_mask:0xf bank_mask:0xf
    s_nop 0
    s_mov_b32 exec_lo, 0x1
    s_mov_b32 exec_hi, 0
    ds_write_b128 v24, v[56:59] offset:2304
    s_mov_b64 exec, -1
    s_waitcnt lgkmcnt(0)
    s_barrier
    s_cmp_lg_u32 s81, 0x8000
    s_cbranch_scc1 L_Anotr
L_Anotr:
    ds_read_b128 v[32:35], v8 offset:1536
    ds_read_b128 v[36:39], v8 offset:1600
    ds_read_b128 v[40:43], v8 offset:1664
    ds_read_b128 v[44:47], v8 offset:1728
    ds_read_b128 v[48:51], v11 offset:2304
    ds_read_b128 v[52:55], v11 offset:2320
    ds_read_b128 v[56:59], v11 offset:2336
    ds_read_b128 v[60:63], v11 offset:2352
    s_waitcnt lgkmcnt(4)
    v_mfma_f32_16x16x32_bf16 v[192:195], v[32:35], v[128:131], 0
    v_mfma_f32_16x16x32_bf16 v[196:199], v[32:35], v[132:135], 0
    v_mfma_f32_16x16x32_bf16 v[200:203], v[32:35], v[136:139], 0
    v_mfma_f32_16x16x32_bf16 v[204:207], v[32:35], v[140:143], 0
    s_waitcnt lgkmcnt(0)
    v_max3_f32 v16, v48, v52, v56
    v_max3_f32 v18, v50, v54, v58
    v_max_f32 v16, v16, v60
    v_max_f32 v18, v18, v62
    v_sub_f32 v48, v48, v16
    v_sub_f32 v50, v50, v18
    v_sub_f32 v52, v52, v16
    v_sub_f32 v54, v54, v18
    v_sub_f32 v56, v56, v16
    v_sub_f32 v58, v58, v18
    v_sub_f32 v60, v60, v16
    v_sub_f32 v62, v62, v18
    v_mfma_f32_16x16x32_bf16 v[208:211], v[36:39], v[144:147], 0
    v_mfma_f32_16x16x32_bf16 v[212:215], v[36:39], v[148:151], 0
    v_mfma_f32_16x16x32_bf16 v[216:219], v[36:39], v[152:155], 0
    v_mfma_f32_16x16x32_bf16 v[220:223], v[36:39], v[156:159], 0
    v_mul_f32 v48, 0x3fb8aa3b, v48
    v_mul_f32 v50, 0x3fb8aa3b, v50
    v_mul_f32 v52, 0x3fb8aa3b, v52
    v_mul_f32 v54, 0x3fb8aa3b, v54
    v_mul_f32 v56, 0x3fb8aa3b, v56
    v_mul_f32 v58, 0x3fb8aa3b, v58
    v_mul_f32 v60, 0x3fb8aa3b, v60
    v_mul_f32 v62, 0x3fb8aa3b, v62
    v_exp_f32 v48, v48
    v_exp_f32 v50, v50
    v_exp_f32 v52, v52
    v_exp_f32 v54, v54
    v_exp_f32 v56, v56
    v_exp_f32 v58, v58
    v_exp_f32 v60, v60
    v_exp_f32 v62, v62
    v_mfma_f32_16x16x32_bf16 v[224:227], v[40:43], v[160:163], 0
    v_mfma_f32_16x16x32_bf16 v[228:231], v[40:43], v[164:167], 0
    v_mfma_f32_16x16x32_bf16 v[232:235], v[40:43], v[168:171], 0
    v_mfma_f32_16x16x32_bf16 v[236:239], v[40:43], v[172:175], 0
    v_mul_f32 v17, v48, v49
    v_mul_f32 v19, v50, v51
    v_fmac_f32 v17, v52, v53
    v_fmac_f32 v19, v54, v55
    v_fmac_f32 v17, v56, v57
    v_fmac_f32 v19, v58, v59
    v_fmac_f32 v17, v60, v61
    v_fmac_f32 v19, v62, v63
    v_mul_f32 v20, v48, v192
    v_mul_f32 v21, v50, v193
    v_mul_f32 v22, v48, v196
    v_mul_f32 v23, v50, v197
    v_mul_f32 v24, v48, v200
    v_mul_f32 v25, v50, v201
    v_mul_f32 v26, v48, v204
    v_mul_f32 v27, v50, v205
    v_mfma_f32_16x16x32_bf16 v[240:243], v[44:47], v[176:179], 0
    v_mfma_f32_16x16x32_bf16 v[244:247], v[44:47], v[180:183], 0
    v_mfma_f32_16x16x32_bf16 v[248:251], v[44:47], v[184:187], 0
    v_mfma_f32_16x16x32_bf16 v[252:255], v[44:47], v[188:191], 0
    v_fmac_f32 v20, v52, v208
    v_fmac_f32 v21, v54, v209
    v_fmac_f32 v22, v52, v212
    v_fmac_f32 v23, v54, v213
    v_fmac_f32 v24, v52, v216
    v_fmac_f32 v25, v54, v217
    v_fmac_f32 v26, v52, v220
    v_fmac_f32 v27, v54, v221
    v_fmac_f32 v20, v56, v224
    v_fmac_f32 v21, v58, v225
    v_fmac_f32 v22, v56, v228
    v_fmac_f32 v23, v58, v229
    v_fmac_f32 v24, v56, v232
    v_fmac_f32 v25, v58, v233
    v_fmac_f32 v26, v56, v236
    v_fmac_f32 v27, v58, v237
    s_nop 1
    v_fmac_f32 v20, v60, v240
    v_fmac_f32 v21, v62, v241
    v_fmac_f32 v22, v60, v244
    v_fmac_f32 v23, v62, v245
    v_fmac_f32 v24, v60, v248
    v_fmac_f32 v25, v62, v249
    v_fmac_f32 v26, v60, v252
    v_fmac_f32 v27, v62, v253
    s_barrier
    s_mov_b32 exec_lo, 0xffff
    s_mov_b32 exec_hi, 0
    buffer_store_dword v20, v10, s[32:35], s52 offen offset:0 sc1
    buffer_store_dword v22, v10, s[32:35], s52 offen offset:2048 sc1
    buffer_store_dword v24, v10, s[32:35], s53 offen offset:0 sc1
    buffer_store_dword v26, v10, s[32:35], s53 offen offset:2048 sc1
    buffer_store_dword v21, v10, s[32:35], s54 offen offset:0 sc1
    buffer_store_dword v23, v10, s[32:35], s54 offen offset:2048 sc1
    buffer_store_dword v25, v10, s[32:35], s55 offen offset:0 sc1
    buffer_store_dword v27, v10, s[32:35], s55 offen offset:2048 sc1
    s_cmp_lg_u32 s30, 0
    s_cbranch_scc1 L_Askipml
    s_mov_b32 exec_lo, 0x1
    s_mov_b32 exec_hi, 0
    buffer_store_dwordx2 v[16:17], v11, s[32:35], s56 offen sc1
    buffer_store_dwordx2 v[18:19], v11, s[32:35], s56 offen offset:256 sc1
L_Askipml:
    s_mov_b64 exec, -1
    v_mov_b32 v24, s30
    v_lshlrev_b32 v24, 4, v24
    s_barrier
    s_cmp_lg_u32 s81, 0x8000
    s_cbranch_scc1 L_Aend
    s_barrier
    s_barrier
    s_barrier
    s_barrier
    s_barrier
    s_add_u32 s81, s81, 0x164000
    s_branch L_Aloop
L_Aend:
    s_endpgm
L_G:
    s_setprio 3
    v_cmp_gt_u32 vcc, 56, v1
    v_mov_b32 v8, 0
    v_lshlrev_b32 v4, 4, v1
    v_cndmask_b32 v2, 0, 1.0, vcc
    v_cndmask_b32 v3, 0, -1, vcc
    v_lshrrev_b32 v9, 4, v1
    v_lshlrev_b32 v5, 4, v9
    v_and_b32 v32, 15, v1
    v_lshrrev_b32 v33, 2, v32
    v_lshl_add_u32 v33, v9, 3, v33
    v_lshlrev_b32 v33, 5, v33
    v_and_b32 v34, 3, v32
    v_lshl_add_u32 v6, v34, 3, v33
    v_lshrrev_b32 v7, 1, v1
    v_lshlrev_b32 v7, 2, v7
    v_mov_b32 v16, 0
    v_mov_b32 v17, 0
    v_mov_b32 v18, 0
    v_mov_b32 v19, 0
    s_cmp_eq_u32 s30, 4
    s_cbranch_scc1 L_G0
    s_cmp_eq_u32 s30, 5
    s_cbranch_scc1 L_G1
    s_cmp_eq_u32 s30, 6
    s_cbranch_scc1 L_G2
    s_branch L_G3
L_G0:
    s_mov_b32 s40, s4
    s_and_b32 s41, s5, 0xffff
    s_mov_b32 s42, 0x380
    s_mov_b32 s43, 0x00020000
    buffer_load_dwordx4 v[16:19], v4, s[40:43], 0 offen
    s_mov_b32 s52, 0x4000
    buffer_load_dword v62, v8, s[32:35], s52 offen sc1
    s_lshl_b32 s87, s31, 10
    s_lshl_b32 s53, s3, 5
    s_add_u32 s87, s87, s53
    s_add_u32 s36, s10, s87
    s_addc_u32 s37, s11, 0
    s_and_b32 s37, s37, 0xffff
    s_mov_b32 s38, 0x380000
    s_mov_b32 s39, 0x00020000
    s_sub_u32 s38, s38, s87
    v_lshrrev_b32 v32, 1, v1
    v_lshlrev_b32 v32, 13, v32
    v_and_b32 v33, 1, v1
    v_lshl_add_u32 v32, v33, 4, v32
    s_mov_b32 s54, 0
    s_mov_b32 s55, 262144
    s_mov_b32 s56, 524288
    s_mov_b32 s57, 786432
    s_mov_b32 s58, 1048576
    s_mov_b32 s59, 1310720
    s_mov_b32 s60, 1572864
    s_mov_b32 s61, 1835008
    s_mov_b32 s62, 2097152
    s_mov_b32 s63, 2359296
    s_mov_b32 s64, 2621440
    s_mov_b32 s65, 2883584
    s_mov_b32 s66, 3145728
    s_mov_b32 s67, 3407872
    buffer_load_dwordx4 v[64:67], v32, s[36:39], s54 offen nt
    buffer_load_dwordx4 v[68:71], v32, s[36:39], s55 offen nt
    buffer_load_dwordx4 v[72:75], v32, s[36:39], s56 offen nt
    buffer_load_dwordx4 v[76:79], v32, s[36:39], s57 offen nt
    buffer_load_dwordx4 v[80:83], v32, s[36:39], s58 offen nt
    buffer_load_dwordx4 v[84:87], v32, s[36:39], s59 offen nt
    buffer_load_dwordx4 v[88:91], v32, s[36:39], s60 offen nt
    buffer_load_dwordx4 v[92:95], v32, s[36:39], s61 offen nt
    buffer_load_dwordx4 v[96:99], v32, s[36:39], s62 offen nt
    buffer_load_dwordx4 v[100:103], v32, s[36:39], s63 offen nt
    buffer_load_dwordx4 v[104:107], v32, s[36:39], s64 offen nt
    buffer_load_dwordx4 v[108:111], v32, s[36:39], s65 offen nt
    buffer_load_dwordx4 v[112:115], v32, s[36:39], s66 offen nt
    buffer_load_dwordx4 v[116:119], v32, s[36:39], s67 offen nt
    s_barrier
    s_waitcnt vmcnt(13)
    ds_write_b128 v4, v[64:67] offset:2432
    s_waitcnt vmcnt(12)
    ds_write_b128 v4, v[68:71] offset:3456
    s_waitcnt vmcnt(11)
    ds_write_b128 v4, v[72:75] offset:4480
    s_waitcnt vmcnt(10)
    ds_write_b128 v4, v[76:79] offset:5504
    s_waitcnt vmcnt(9)
    ds_write_b128 v4, v[80:83] offset:6528
    s_waitcnt vmcnt(8)
    ds_write_b128 v4, v[84:87] offset:7552
    s_waitcnt vmcnt(7)
    ds_write_b128 v4, v[88:91] offset:8576
    s_waitcnt vmcnt(6)
    ds_write_b128 v4, v[92:95] offset:9600
    s_waitcnt vmcnt(5)
    ds_write_b128 v4, v[96:99] offset:10624
    s_waitcnt vmcnt(4)
    ds_write_b128 v4, v[100:103] offset:11648
    s_waitcnt vmcnt(3)
    ds_write_b128 v4, v[104:107] offset:12672
    s_waitcnt vmcnt(2)
    ds_write_b128 v4, v[108:111] offset:13696
    s_waitcnt vmcnt(1)
    ds_write_b128 v4, v[112:115] offset:14720
    s_waitcnt vmcnt(0)
    ds_write_b128 v4, v[116:119] offset:15744
    s_waitcnt lgkmcnt(0)
    ds_read_b64_tr_b16 v[64:65], v6 offset:2432
    ds_read_b64_tr_b16 v[66:67], v6 offset:2560
    ds_read_b64_tr_b16 v[68:69], v6 offset:3456
    ds_read_b64_tr_b16 v[70:71], v6 offset:3584
    ds_read_b64_tr_b16 v[72:73], v6 offset:4480
    ds_read_b64_tr_b16 v[74:75], v6 offset:4608
    ds_read_b64_tr_b16 v[76:77], v6 offset:5504
    ds_read_b64_tr_b16 v[78:79], v6 offset:5632
    ds_read_b64_tr_b16 v[80:81], v6 offset:6528
    ds_read_b64_tr_b16 v[82:83], v6 offset:6656
    ds_read_b64_tr_b16 v[84:85], v6 offset:7552
    ds_read_b64_tr_b16 v[86:87], v6 offset:7680
    ds_read_b64_tr_b16 v[88:89], v6 offset:8576
    ds_read_b64_tr_b16 v[90:91], v6 offset:8704
    ds_read_b64_tr_b16 v[92:93], v6 offset:9600
    ds_read_b64_tr_b16 v[94:95], v6 offset:9728
    ds_read_b64_tr_b16 v[96:97], v6 offset:10624
    ds_read_b64_tr_b16 v[98:99], v6 offset:10752
    ds_read_b64_tr_b16 v[100:101], v6 offset:11648
    ds_read_b64_tr_b16 v[102:103], v6 offset:11776
    ds_read_b64_tr_b16 v[104:105], v6 offset:12672
    ds_read_b64_tr_b16 v[106:107], v6 offset:12800
    ds_read_b64_tr_b16 v[108:109], v6 offset:13696
    ds_read_b64_tr_b16 v[110:111], v6 offset:13824
    ds_read_b64_tr_b16 v[112:113], v6 offset:14720
    ds_read_b64_tr_b16 v[114:115], v6 offset:14848
    ds_read_b64_tr_b16 v[116:117], v6 offset:15744
    ds_read_b64_tr_b16 v[118:119], v6 offset:15872
    s_waitcnt lgkmcnt(0)
    v_readfirstlane_b32 s94, v62
    s_add_u32 s94, s94, 0x9e3779b9
    v_lshlrev_b32 v10, 1, v7
L_G0loop:
    v_lshlrev_b32 v24, 16, v16
    v_and_b32 v25, 0xffff0000, v16
    v_lshlrev_b32 v26, 16, v17
    v_and_b32 v27, 0xffff0000, v17
    v_lshlrev_b32 v28, 16, v18
    v_and_b32 v29, 0xffff0000, v18
    v_lshlrev_b32 v30, 16, v19
    v_and_b32 v31, 0xffff0000, v19
    v_readlane_b32 s52, v24, 0
    s_nop 0
    s_mov_b32 s53, s52
    s_nop 0
    v_pk_add_f32 v[32:33], v[24:25], s[52:53] neg_lo:[0,1] neg_hi:[0,1]
    v_pk_add_f32 v[34:35], v[26:27], s[52:53] neg_lo:[0,1] neg_hi:[0,1]
    v_pk_add_f32 v[36:37], v[28:29], s[52:53] neg_lo:[0,1] neg_hi:[0,1]
    v_pk_add_f32 v[38:39], v[30:31], s[52:53] neg_lo:[0,1] neg_hi:[0,1]
    v_pk_add_f32 v[40:41], v[32:33], v[34:35]
    v_pk_mul_f32 v[42:43], v[32:33], v[32:33]
    v_pk_add_f32 v[44:45], v[36:37], v[38:39]
    v_pk_fma_f32 v[42:43], v[34:35], v[34:35], v[42:43]
    v_pk_add_f32 v[40:41], v[40:41], v[44:45]
    v_pk_fma_f32 v[42:43], v[36:37], v[36:37], v[42:43]
    v_add_f32 v40, v40, v41
    v_pk_fma_f32 v[42:43], v[38:39], v[38:39], v[42:43]
    v_mul_f32 v40, v40, v2
    v_add_f32 v41, v42, v43
    v_mul_f32 v41, v41, v2
    s_nop 1
    v_add_f32_dpp v40, v40, v40 row_ror:8 row_mask:0xf bank_mask:0xf
    v_add_f32_dpp v41, v41, v41 row_ror:8 row_mask:0xf bank_mask:0xf
    s_nop 0
    v_add_f32_dpp v40, v40, v40 row_ror:4 row_mask:0xf bank_mask:0xf
    v_add_f32_dpp v41, v41, v41 row_ror:4 row_mask:0xf bank_mask:0xf
    s_nop 0
    v_add_f32_dpp v40, v40, v40 row_ror:2 row_mask:0xf bank_mask:0xf
    v_add_f32_dpp v41, v41, v41 row_ror:2 row_mask:0xf bank_mask:0xf
    s_nop 0
    v_add_f32_dpp v40, v40, v40 row_ror:1 row_mask:0xf bank_mask:0xf
    v_add_f32_dpp v41, v41, v41 row_ror:1 row_mask:0xf bank_mask:0xf
    s_nop 0
    v_add_f32_dpp v40, v40, v40 row_bcast:15 row_mask:0xa bank_mask:0xf
    v_add_f32_dpp v41, v41, v41 row_bcast:15 row_mask:0xa bank_mask:0xf
    s_nop 0
    v_add_f32_dpp v40, v40, v40 row_bcast:31 row_mask:0xc bank_mask:0xf
    v_add_f32_dpp v41, v41, v41 row_bcast:31 row_mask:0xc bank_mask:0xf
    s_nop 0
    v_readlane_b32 s54, v40, 63
    v_readlane_b32 s55, v41, 63
    v_mov_b32 v42, 0x3b124925
    s_nop 0
    v_mul_f32 v40, s54, v42
    v_mul_f32 v41, s55, v42
    v_fma_f32 v41, -v40, v40, v41
    v_add_f32 v40, s52, v40
    v_max_f32 v41, 0, v41
    v_cvt_pk_bf16_f32 v43, v40, v41
    v_lshlrev_b32 v40, 16, v43
    v_and_b32 v42, 0xffff0000, v43
    v_add_f32 v42, 0x3727c5ac, v42
    v_pk_add_f32 v[32:33], v[24:25], v[40:41] op_sel_hi:[1,0] neg_lo:[0,1] neg_hi:[0,1]
    v_pk_add_f32 v[34:35], v[26:27], v[40:41] op_sel_hi:[1,0] neg_lo:[0,1] neg_hi:[0,1]
    v_pk_add_f32 v[36:37], v[28:29], v[40:41] op_sel_hi:[1,0] neg_lo:[0,1] neg_hi:[0,1]
    v_pk_add_f32 v[38:39], v[30:31], v[40:41] op_sel_hi:[1,0] neg_lo:[0,1] neg_hi:[0,1]
    v_cvt_pk_bf16_f32 v42, v42, v42
    v_cvt_pk_bf16_f32 v24, v32, v33
    v_and_b32 v42, 0xffff0000, v42
    v_cvt_pk_bf16_f32 v25, v34, v35
    v_sqrt_f32 v42, v42
    v_cvt_pk_bf16_f32 v26, v36, v37
    v_cvt_pk_bf16_f32 v27, v38, v39
    v_cvt_pk_bf16_f32 v42, v42, v42
    v_lshlrev_b32 v32, 16, v24
    v_and_b32 v33, 0xffff0000, v24
    v_lshlrev_b32 v34, 16, v25
    v_and_b32 v35, 0xffff0000, v25
    v_and_b32 v42, 0xffff0000, v42
    v_lshlrev_b32 v36, 16, v26
    v_and_b32 v37, 0xffff0000, v26
    v_lshlrev_b32 v38, 16, v27
    v_and_b32 v39, 0xffff0000, v27
    v_rcp_f32 v42, v42
    s_nop 0
    v_pk_mul_f32 v[32:33], v[32:33], v[42:43] op_sel_hi:[1,0]
    v_pk_mul_f32 v[34:35], v[34:35], v[42:43] op_sel_hi:[1,0]
    v_pk_mul_f32 v[36:37], v[36:37], v[42:43] op_sel_hi:[1,0]
    v_pk_mul_f32 v[38:39], v[38:39], v[42:43] op_sel_hi:[1,0]
    v_cvt_pk_bf16_f32 v20, v32, v33
    v_cvt_pk_bf16_f32 v21, v34, v35
    v_cvt_pk_bf16_f32 v22, v36, v37
    v_cvt_pk_bf16_f32 v23, v38, v39
    ds_write_b128 v4, v[20:23] offset:31104
    s_waitcnt lgkmcnt(0)
    ds_read_b128 v[128:131], v5 offset:31104
    ds_read_b128 v[132:135], v5 offset:31168
    ds_read_b128 v[136:139], v5 offset:31232
    ds_read_b128 v[140:143], v5 offset:31296
    ds_read_b128 v[144:147], v5 offset:31360
    ds_read_b128 v[148:151], v5 offset:31424
    ds_read_b128 v[152:155], v5 offset:31488
    ds_read_b128 v[156:159], v5 offset:31552
    ds_read_b128 v[160:163], v5 offset:31616
    ds_read_b128 v[164:167], v5 offset:31680
    ds_read_b128 v[168:171], v5 offset:31744
    ds_read_b128 v[172:175], v5 offset:31808
    ds_read_b128 v[176:179], v5 offset:31872
    ds_read_b128 v[180:183], v5 offset:31936
    s_waitcnt lgkmcnt(13)
    v_mfma_f32_16x16x32_bf16 v[48:51], v[128:131], v[64:67], 0
    s_waitcnt lgkmcnt(12)
    v_mfma_f32_16x16x32_bf16 v[48:51], v[132:135], v[68:71], v[48:51]
    s_waitcnt lgkmcnt(11)
    v_mfma_f32_16x16x32_bf16 v[48:51], v[136:139], v[72:75], v[48:51]
    s_waitcnt lgkmcnt(10)
    v_mfma_f32_16x16x32_bf16 v[48:51], v[140:143], v[76:79], v[48:51]
    s_waitcnt lgkmcnt(9)
    v_mfma_f32_16x16x32_bf16 v[48:51], v[144:147], v[80:83], v[48:51]
    s_waitcnt lgkmcnt(8)
    v_mfma_f32_16x16x32_bf16 v[48:51], v[148:151], v[84:87], v[48:51]
    s_waitcnt lgkmcnt(7)
    v_mfma_f32_16x16x32_bf16 v[48:51], v[152:155], v[88:91], v[48:51]
    s_waitcnt lgkmcnt(6)
    v_mfma_f32_16x16x32_bf16 v[48:51], v[156:159], v[92:95], v[48:51]
    s_waitcnt lgkmcnt(5)
    v_mfma_f32_16x16x32_bf16 v[48:51], v[160:163], v[96:99], v[48:51]
    s_waitcnt lgkmcnt(4)
    v_mfma_f32_16x16x32_bf16 v[48:51], v[164:167], v[100:103], v[48:51]
    s_waitcnt lgkmcnt(3)
    v_mfma_f32_16x16x32_bf16 v[48:51], v[168:171], v[104:107], v[48:51]
    s_waitcnt lgkmcnt(2)
    v_mfma_f32_16x16x32_bf16 v[48:51], v[172:175], v[108:111], v[48:51]
    s_waitcnt lgkmcnt(1)
    v_mfma_f32_16x16x32_bf16 v[48:51], v[176:179], v[112:115], v[48:51]
    s_waitcnt lgkmcnt(0)
    v_mfma_f32_16x16x32_bf16 v[48:51], v[180:183], v[116:119], v[48:51]
    s_nop 7
    s_nop 1
    v_mov_b32_dpp v40, v48 quad_perm:[1,0,3,2] row_mask:0xf bank_mask:0xf
    v_mov_b32 v41, s94
    v_cvt_pk_bf16_f32 v40, v48, v40
    s_mov_b32 exec_lo, 0x5555
    s_mov_b32 exec_hi, 0
    s_cmp_lg_u32 s81, 0x8000
    s_cbranch_scc1 L_G0second
    s_lshl_b32 s52, s87, 1
    buffer_store_dwordx2 v[40:41], v10, s[32:35], s52 offen sc1
    s_mov_b64 exec, -1
    s_sleep 64
    s_sleep 6
    v_lshlrev_b32 v40, 5, v1
    s_mov_b32 s80, 0
    s_mov_b32 s53, 0x5000
    buffer_load_dwordx4 v[48:51], v40, s[32:35], s53 offen sc1
    buffer_load_dwordx4 v[52:55], v40, s[32:35], s53 offen offset:16 sc1
    s_barrier
    s_barrier
    s_branch L_flagchk
L_flagpoll:
    buffer_load_dwordx4 v[48:51], v40, s[32:35], s53 offen sc1
    buffer_load_dwordx4 v[52:55], v40, s[32:35], s53 offen offset:16 sc1
L_flagchk:
    s_waitcnt vmcnt(0)
    v_xor_b32 v48, s94, v48
    v_xor_b32 v49, s94, v49
    v_xor_b32 v50, s94, v50
    v_xor_b32 v51, s94, v51
    v_xor_b32 v52, s94, v52
    v_xor_b32 v53, s94, v53
    v_xor_b32 v54, s94, v54
    v_xor_b32 v55, s94, v55
    v_or3_b32 v48, v48, v49, v50
    v_or3_b32 v51, v51, v52, v53
    v_or3_b32 v48, v48, v54, v55
    v_or_b32 v48, v48, v51
    v_cmp_ne_u32 vcc, 0, v48
    s_add_u32 s80, s80, 1
    s_cbranch_vccz L_flagdone
    s_sleep 8
    s_cmp_lt_u32 s80, 0x100000
    s_cbranch_scc1 L_flagpoll
L_flagdone:
    s_barrier
    s_barrier
    s_barrier
    s_barrier
    s_barrier
    s_barrier
    s_add_u32 s60, s81, 0x161400
    s_mov_b32 exec_lo, -1
    s_mov_b32 exec_hi, 0xffffff
    s_sleep 26
    s_mov_b32 s80, 0
Lpoll_1:
    buffer_load_dwordx4 v[16:19], v4, s[32:35], s60 offen offset:0 sc1
    s_waitcnt vmcnt(0)
    v_max3_u32 v40, v16, v17, v18
    v_max_u32 v40, v40, v19
    v_cmp_eq_u32 vcc, -1, v40
    s_add_u32 s80, s80, 1
    s_cbranch_vccz Lpolld_2
    s_sleep 1
    s_cmp_lt_u32 s80, 0x100000
    s_cbranch_scc1 Lpoll_1
Lpolld_2:
    s_mov_b64 exec, -1
    s_add_u32 s81, s81, 0x164000
    s_branch L_G0loop
L_G0second:
    s_add_u32 s52, s87, 0x16a000
    buffer_store_dword v40, v7, s[32:35], s52 offen sc1
    s_mov_b64 exec, -1
    s_barrier
    s_endpgm
L_G1:
    s_barrier
    s_setprio 0
    s_sleep 64
    s_sleep 64
    s_sleep 22
    s_mul_i32 s87, s31, 224
    s_lshl_b32 s53, s101, 3
    s_add_u32 s87, s87, s53
    s_mov_b32 s40, s18
    s_and_b32 s41, s19, 0xffff
    s_mov_b32 s42, 0xe00
    s_mov_b32 s43, 0x00020000
    v_lshlrev_b32 v40, 1, v1
    s_lshl_b32 s92, s87, 1
    buffer_load_ushort v12, v40, s[40:43], s92 offen
    s_add_u32 s36, s16, s92
    s_addc_u32 s37, s17, 0
    s_and_b32 s37, s37, 0xffff
    s_mov_b32 s38, 0x188000
    s_mov_b32 s39, 0x00020000
    s_sub_u32 s38, s38, s92
    s_mov_b32 s53, 3584
    v_mul_lo_u32 v32, v1, s53
    s_cmp_ge_u32 s3, 28
    s_cbranch_scc1 L_G1skipw
    s_mov_b32 s54, 0
    s_mov_b32 s55, 229376
    s_mov_b32 s56, 458752
    s_mov_b32 s57, 688128
    s_mov_b32 s58, 917504
    s_mov_b32 s59, 1146880
    s_mov_b32 s60, 1376256
    buffer_load_dwordx4 v[64:67], v32, s[36:39], s54 offen nt
    buffer_load_dwordx4 v[68:71], v32, s[36:39], s55 offen nt
    buffer_load_dwordx4 v[72:75], v32, s[36:39], s56 offen nt
    buffer_load_dwordx4 v[76:79], v32, s[36:39], s57 offen nt
    buffer_load_dwordx4 v[80:83], v32, s[36:39], s58 offen nt
    buffer_load_dwordx4 v[84:87], v32, s[36:39], s59 offen nt
    buffer_load_dwordx4 v[88:91], v32, s[36:39], s60 offen nt
    s_mul_i32 s52, s87, 896
    s_add_u32 s44, s20, s52
    s_addc_u32 s45, s21, 0
    s_and_b32 s45, s45, 0xffff
    s_mov_b32 s46, 0x1c00
    s_mov_b32 s47, 0x00020000
    s_mov_b32 s53, 0
    s_mov_b32 s54, 3584
    s_mov_b32 exec_lo, -1
    s_mov_b32 exec_hi, 0xffffff
    buffer_load_dwordx4 v[128:131], v4, s[44:47], s53 offen offset:0 nt
    buffer_load_dwordx4 v[132:135], v4, s[44:47], s53 offen offset:896 nt
    buffer_load_dwordx4 v[136:139], v4, s[44:47], s53 offen offset:1792 nt
    buffer_load_dwordx4 v[140:143], v4, s[44:47], s53 offen offset:2688 nt
    buffer_load_dwordx4 v[144:147], v4, s[44:47], s54 offen offset:0 nt
    buffer_load_dwordx4 v[148:151], v4, s[44:47], s54 offen offset:896 nt
    buffer_load_dwordx4 v[152:155], v4, s[44:47], s54 offen offset:1792 nt
    buffer_load_dwordx4 v[156:159], v4, s[44:47], s54 offen offset:2688 nt
    s_mov_b64 exec, -1
L_G1skipw:
    s_setprio 3
    s_barrier
    s_barrier
    s_barrier
    s_barrier
    s_barrier
    s_waitcnt vmcnt(0)
    v_lshlrev_b32 v40, 5, v1
    ds_write_b128 v40, v[64:67] offset:16768
    ds_write_b128 v40, v[68:71] offset:18816
    ds_write_b128 v40, v[72:75] offset:20864
    ds_write_b128 v40, v[76:79] offset:22912
    ds_write_b128 v40, v[80:83] offset:24960
    ds_write_b128 v40, v[84:87] offset:27008
    ds_write_b128 v40, v[88:91] offset:29056
    s_waitcnt lgkmcnt(0)
    ds_read_b64_tr_b16 v[64:65], v6 offset:16768
    ds_read_b64_tr_b16 v[66:67], v6 offset:16896
    ds_read_b64_tr_b16 v[68:69], v6 offset:17792
    ds_read_b64_tr_b16 v[70:71], v6 offset:17920
    ds_read_b64_tr_b16 v[72:73], v6 offset:18816
    ds_read_b64_tr_b16 v[74:75], v6 offset:18944
    ds_read_b64_tr_b16 v[76:77], v6 offset:19840
    ds_read_b64_tr_b16 v[78:79], v6 offset:19968
    ds_read_b64_tr_b16 v[80:81], v6 offset:20864
    ds_read_b64_tr_b16 v[82:83], v6 offset:20992
    ds_read_b64_tr_b16 v[84:85], v6 offset:21888
    ds_read_b64_tr_b16 v[86:87], v6 offset:22016
    ds_read_b64_tr_b16 v[88:89], v6 offset:22912
    ds_read_b64_tr_b16 v[90:91], v6 offset:23040
    ds_read_b64_tr_b16 v[92:93], v6 offset:23936
    ds_read_b64_tr_b16 v[94:95], v6 offset:24064
    ds_read_b64_tr_b16 v[96:97], v6 offset:24960
    ds_read_b64_tr_b16 v[98:99], v6 offset:25088
    ds_read_b64_tr_b16 v[100:101], v6 offset:25984
    ds_read_b64_tr_b16 v[102:103], v6 offset:26112
    ds_read_b64_tr_b16 v[104:105], v6 offset:27008
    ds_read_b64_tr_b16 v[106:107], v6 offset:27136
    ds_read_b64_tr_b16 v[108:109], v6 offset:28032
    ds_read_b64_tr_b16 v[110:111], v6 offset:28160
    ds_read_b64_tr_b16 v[112:113], v6 offset:29056
    ds_read_b64_tr_b16 v[114:115], v6 offset:29184
    ds_read_b64_tr_b16 v[116:117], v6 offset:30080
    ds_read_b64_tr_b16 v[118:119], v6 offset:30208
    s_waitcnt lgkmcnt(0)
    v_perm_b32 v192, v132, v128, s82
    v_perm_b32 v193, v132, v128, s83
    v_perm_b32 v194, v133, v129, s82
    v_perm_b32 v195, v133, v129, s83
    v_perm_b32 v196, v134, v130, s82
    v_perm_b32 v197, v134, v130, s83
    v_perm_b32 v198, v135, v131, s82
    v_perm_b32 v199, v135, v131, s83
    v_perm_b32 v200, v140, v136, s82
    v_perm_b32 v201, v140, v136, s83
    v_perm_b32 v202, v141, v137, s82
    v_perm_b32 v203, v141, v137, s83
    v_perm_b32 v204, v142, v138, s82
    v_perm_b32 v205, v142, v138, s83
    v_perm_b32 v206, v143, v139, s82
    v_perm_b32 v207, v143, v139, s83
    v_perm_b32 v208, v148, v144, s82
    v_perm_b32 v209, v148, v144, s83
    v_perm_b32 v210, v149, v145, s82
    v_perm_b32 v211, v149, v145, s83
    v_perm_b32 v212, v150, v146, s82
    v_perm_b32 v213, v150, v146, s83
    v_perm_b32 v214, v151, v147, s82
    v_perm_b32 v215, v151, v147, s83
    v_perm_b32 v216, v156, v152, s82
    v_perm_b32 v217, v156, v152, s83
    v_perm_b32 v218, v157, v153, s82
    v_perm_b32 v219, v157, v153, s83
    v_perm_b32 v220, v158, v154, s82
    v_perm_b32 v221, v158, v154, s83
    v_perm_b32 v222, v159, v155, s82
    v_perm_b32 v223, v159, v155, s83
    v_lshlrev_b32 v12, 16, v12
    v_lshlrev_b32 v10, 13, v1
    v_add_u32 v11, 4096, v10
    s_mul_i32 s93, s31, 28
    s_add_u32 s93, s93, s101
    s_lshl_b32 s93, s93, 4
    s_add_u32 s93, s93, 0xf0000
    s_cmp_ge_u32 s3, 28
    s_cbranch_scc1 L_G1noclr
    s_mul_i32 s52, s31, 28
    s_add_u32 s52, s52, s3
    s_mul_i32 s52, s52, 7168
    s_add_u32 s52, s52, 0x16c000
    s_add_u32 s53, s52, 4096
    v_mov_b32 v24, -1
    v_mov_b32 v25, -1
    v_mov_b32 v26, -1
    v_mov_b32 v27, -1
    buffer_store_dwordx4 v[24:27], v4, s[32:35], s52 offen offset:0 sc1
    buffer_store_dwordx4 v[24:27], v4, s[32:35], s52 offen offset:1024 sc1
    buffer_store_dwordx4 v[24:27], v4, s[32:35], s52 offen offset:2048 sc1
    buffer_store_dwordx4 v[24:27], v4, s[32:35], s52 offen offset:3072 sc1
    buffer_store_dwordx4 v[24:27], v4, s[32:35], s53 offen offset:0 sc1
    buffer_store_dwordx4 v[24:27], v4, s[32:35], s53 offen offset:1024 sc1
    buffer_store_dwordx4 v[24:27], v4, s[32:35], s53 offen offset:2048 sc1
L_G1noclr:
L_G1loop:
    s_barrier
    s_add_u32 s60, s81, 0x161000
    s_mov_b32 exec_lo, -1
    s_mov_b32 exec_hi, 0xffffff
    s_sleep 26
    s_mov_b32 s80, 0
Lpoll_3:
    buffer_load_dwordx4 v[16:19], v4, s[32:35], s60 offen offset:0 sc1
    s_waitcnt vmcnt(0)
    v_max3_u32 v40, v16, v17, v18
    v_max_u32 v40, v40, v19
    v_cmp_eq_u32 vcc, -1, v40
    s_add_u32 s80, s80, 1
    s_cbranch_vccz Lpolld_4
    s_sleep 1
    s_cmp_lt_u32 s80, 0x100000
    s_cbranch_scc1 Lpoll_3
Lpolld_4:
    s_mov_b64 exec, -1
    v_lshlrev_b32 v24, 16, v16
    v_and_b32 v25, 0xffff0000, v16
    v_lshlrev_b32 v26, 16, v17
    v_and_b32 v27, 0xffff0000, v17
    v_lshlrev_b32 v28, 16, v18
    v_and_b32 v29, 0xffff0000, v18
    v_lshlrev_b32 v30, 16, v19
    v_and_b32 v31, 0xffff0000, v19
    v_readlane_b32 s52, v24, 0
    s_nop 0
    s_mov_b32 s53, s52
    s_nop 0
    v_pk_add_f32 v[32:33], v[24:25], s[52:53] neg_lo:[0,1] neg_hi:[0,1]
    v_pk_add_f32 v[34:35], v[26:27], s[52:53] neg_lo:[0,1] neg_hi:[0,1]
    v_pk_add_f32 v[36:37], v[28:29], s[52:53] neg_lo:[0,1] neg_hi:[0,1]
    v_pk_add_f32 v[38:39], v[30:31], s[52:53] neg_lo:[0,1] neg_hi:[0,1]
    v_pk_add_f32 v[40:41], v[32:33], v[34:35]
    v_pk_mul_f32 v[42:43], v[32:33], v[32:33]
    v_pk_add_f32 v[44:45], v[36:37], v[38:39]
    v_pk_fma_f32 v[42:43], v[34:35], v[34:35], v[42:43]
    v_pk_add_f32 v[40:41], v[40:41], v[44:45]
    v_pk_fma_f32 v[42:43], v[36:37], v[36:37], v[42:43]
    v_add_f32 v40, v40, v41
    v_pk_fma_f32 v[42:43], v[38:39], v[38:39], v[42:43]
    v_mul_f32 v40, v40, v2
    v_add_f32 v41, v42, v43
    v_mul_f32 v41, v41, v2
    s_nop 1
    v_add_f32_dpp v40, v40, v40 row_ror:8 row_mask:0xf bank_mask:0xf
    v_add_f32_dpp v41, v41, v41 row_ror:8 row_mask:0xf bank_mask:0xf
    s_nop 0
    v_add_f32_dpp v40, v40, v40 row_ror:4 row_mask:0xf bank_mask:0xf
    v_add_f32_dpp v41, v41, v41 row_ror:4 row_mask:0xf bank_mask:0xf
    s_nop 0
    v_add_f32_dpp v40, v40, v40 row_ror:2 row_mask:0xf bank_mask:0xf
    v_add_f32_dpp v41, v41, v41 row_ror:2 row_mask:0xf bank_mask:0xf
    s_nop 0
    v_add_f32_dpp v40, v40, v40 row_ror:1 row_mask:0xf bank_mask:0xf
    v_add_f32_dpp v41, v41, v41 row_ror:1 row_mask:0xf bank_mask:0xf
    s_nop 0
    v_add_f32_dpp v40, v40, v40 row_bcast:15 row_mask:0xa bank_mask:0xf
    v_add_f32_dpp v41, v41, v41 row_bcast:15 row_mask:0xa bank_mask:0xf
    s_nop 0
    v_add_f32_dpp v40, v40, v40 row_bcast:31 row_mask:0xc bank_mask:0xf
    v_add_f32_dpp v41, v41, v41 row_bcast:31 row_mask:0xc bank_mask:0xf
    s_nop 0
    v_readlane_b32 s54, v40, 63
    v_readlane_b32 s55, v41, 63
    v_mov_b32 v42, 0x3b124925
    s_nop 0
    v_mul_f32 v40, s54, v42
    v_mul_f32 v41, s55, v42
    v_fma_f32 v41, -v40, v40, v41
    v_add_f32 v40, s52, v40
    v_max_f32 v41, 0, v41
    v_cvt_pk_bf16_f32 v43, v40, v41
    v_lshlrev_b32 v40, 16, v43
    v_and_b32 v42, 0xffff0000, v43
    v_add_f32 v42, 0x3727c5ac, v42
    v_pk_add_f32 v[32:33], v[24:25], v[40:41] op_sel_hi:[1,0] neg_lo:[0,1] neg_hi:[0,1]
    v_pk_add_f32 v[34:35], v[26:27], v[40:41] op_sel_hi:[1,0] neg_lo:[0,1] neg_hi:[0,1]
    v_pk_add_f32 v[36:37], v[28:29], v[40:41] op_sel_hi:[1,0] neg_lo:[0,1] neg_hi:[0,1]
    v_pk_add_f32 v[38:39], v[30:31], v[40:41] op_sel_hi:[1,0] neg_lo:[0,1] neg_hi:[0,1]
    v_cvt_pk_bf16_f32 v42, v42, v42
    v_cvt_pk_bf16_f32 v24, v32, v33
    v_and_b32 v42, 0xffff0000, v42
    v_cvt_pk_bf16_f32 v25, v34, v35
    v_sqrt_f32 v42, v42
    v_cvt_pk_bf16_f32 v26, v36, v37
    v_cvt_pk_bf16_f32 v27, v38, v39
    v_cvt_pk_bf16_f32 v42, v42, v42
    v_lshlrev_b32 v32, 16, v24
    v_and_b32 v33, 0xffff0000, v24
    v_lshlrev_b32 v34, 16, v25
    v_and_b32 v35, 0xffff0000, v25
    v_and_b32 v42, 0xffff0000, v42
    v_lshlrev_b32 v36, 16, v26
    v_and_b32 v37, 0xffff0000, v26
    v_lshlrev_b32 v38, 16, v27
    v_and_b32 v39, 0xffff0000, v27
    v_rcp_f32 v42, v42
    s_nop 0
    v_pk_mul_f32 v[32:33], v[32:33], v[42:43] op_sel_hi:[1,0]
    v_pk_mul_f32 v[34:35], v[34:35], v[42:43] op_sel_hi:[1,0]
    v_pk_mul_f32 v[36:37], v[36:37], v[42:43] op_sel_hi:[1,0]
    v_pk_mul_f32 v[38:39], v[38:39], v[42:43] op_sel_hi:[1,0]
    v_cvt_pk_bf16_f32 v20, v32, v33
    v_cvt_pk_bf16_f32 v21, v34, v35
    v_cvt_pk_bf16_f32 v22, v36, v37
    v_cvt_pk_bf16_f32 v23, v38, v39
    v_and_b32 v20, v20, v3
    v_and_b32 v21, v21, v3
    v_and_b32 v22, v22, v3
    v_and_b32 v23, v23, v3
    v_lshlrev_b32 v24, 16, v20
    v_and_b32 v25, 0xffff0000, v20
    v_lshlrev_b32 v26, 16, v21
    v_and_b32 v27, 0xffff0000, v21
    v_lshlrev_b32 v28, 16, v22
    v_and_b32 v29, 0xffff0000, v22
    v_lshlrev_b32 v30, 16, v23
    v_and_b32 v31, 0xffff0000, v23
    v_readlane_b32 s52, v24, 0
    s_nop 0
    s_mov_b32 s53, s52
    s_nop 0
    v_pk_add_f32 v[32:33], v[24:25], s[52:53] neg_lo:[0,1] neg_hi:[0,1]
    v_pk_add_f32 v[34:35], v[26:27], s[52:53] neg_lo:[0,1] neg_hi:[0,1]
    v_pk_add_f32 v[36:37], v[28:29], s[52:53] neg_lo:[0,1] neg_hi:[0,1]
    v_pk_add_f32 v[38:39], v[30:31], s[52:53] neg_lo:[0,1] neg_hi:[0,1]
    v_pk_add_f32 v[40:41], v[32:33], v[34:35]
    v_pk_mul_f32 v[42:43], v[32:33], v[32:33]
    v_pk_add_f32 v[44:45], v[36:37], v[38:39]
    v_pk_fma_f32 v[42:43], v[34:35], v[34:35], v[42:43]
    v_pk_add_f32 v[40:41], v[40:41], v[44:45]
    v_pk_fma_f32 v[42:43], v[36:37], v[36:37], v[42:43]
    v_add_f32 v40, v40, v41
    v_pk_fma_f32 v[42:43], v[38:39], v[38:39], v[42:43]
    v_mul_f32 v40, v40, v2
    v_add_f32 v41, v42, v43
    v_mul_f32 v41, v41, v2
    s_nop 1
    v_add_f32_dpp v40, v40, v40 row_ror:8 row_mask:0xf bank_mask:0xf
    v_add_f32_dpp v41, v41, v41 row_ror:8 row_mask:0xf bank_mask:0xf
    s_nop 0
    v_add_f32_dpp v40, v40, v40 row_ror:4 row_mask:0xf bank_mask:0xf
    v_add_f32_dpp v41, v41, v41 row_ror:4 row_mask:0xf bank_mask:0xf
    s_nop 0
    v_add_f32_dpp v40, v40, v40 row_ror:2 row_mask:0xf bank_mask:0xf
    v_add_f32_dpp v41, v41, v41 row_ror:2 row_mask:0xf bank_mask:0xf
    s_nop 0
    v_add_f32_dpp v40, v40, v40 row_ror:1 row_mask:0xf bank_mask:0xf
    v_add_f32_dpp v41, v41, v41 row_ror:1 row_mask:0xf bank_mask:0xf
    s_nop 0
    v_add_f32_dpp v40, v40, v40 row_bcast:15 row_mask:0xa bank_mask:0xf
    v_add_f32_dpp v41, v41, v41 row_bcast:15 row_mask:0xa bank_mask:0xf
    s_nop 0
    v_add_f32_dpp v40, v40, v40 row_bcast:31 row_mask:0xc bank_mask:0xf
    v_add_f32_dpp v41, v41, v41 row_bcast:31 row_mask:0xc bank_mask:0xf
    s_nop 0
    v_readlane_b32 s54, v40, 63
    v_readlane_b32 s55, v41, 63
    v_mov_b32 v42, 0x3b124925
    s_nop 0
    v_mul_f32 v40, s54, v42
    v_mul_f32 v41, s55, v42
    v_fma_f32 v41, -v40, v40, v41
    v_add_f32 v40, s52, v40
    v_max_f32 v41, 0, v41
    v_cvt_pk_bf16_f32 v43, v40, v41
    v_lshlrev_b32 v40, 16, v43
    v_and_b32 v42, 0xffff0000, v43
    v_add_f32 v42, 0x3727c5ac, v42
    v_pk_add_f32 v[32:33], v[24:25], v[40:41] op_sel_hi:[1,0] neg_lo:[0,1] neg_hi:[0,1]
    v_pk_add_f32 v[34:35], v[26:27], v[40:41] op_sel_hi:[1,0] neg_lo:[0,1] neg_hi:[0,1]
    v_pk_add_f32 v[36:37], v[28:29], v[40:41] op_sel_hi:[1,0] neg_lo:[0,1] neg_hi:[0,1]
    v_pk_add_f32 v[38:39], v[30:31], v[40:41] op_sel_hi:[1,0] neg_lo:[0,1] neg_hi:[0,1]
    v_cvt_pk_bf16_f32 v42, v42, v42
    v_cvt_pk_bf16_f32 v24, v32, v33
    v_and_b32 v42, 0xffff0000, v42
    v_cvt_pk_bf16_f32 v25, v34, v35
    v_sqrt_f32 v42, v42
    v_cvt_pk_bf16_f32 v26, v36, v37
    v_cvt_pk_bf16_f32 v27, v38, v39
    v_cvt_pk_bf16_f32 v42, v42, v42
    v_lshlrev_b32 v32, 16, v24
    v_and_b32 v33, 0xffff0000, v24
    v_lshlrev_b32 v34, 16, v25
    v_and_b32 v35, 0xffff0000, v25
    v_and_b32 v42, 0xffff0000, v42
    v_lshlrev_b32 v36, 16, v26
    v_and_b32 v37, 0xffff0000, v26
    v_lshlrev_b32 v38, 16, v27
    v_and_b32 v39, 0xffff0000, v27
    v_rcp_f32 v42, v42
    s_nop 0
    v_pk_mul_f32 v[32:33], v[32:33], v[42:43] op_sel_hi:[1,0]
    v_pk_mul_f32 v[34:35], v[34:35], v[42:43] op_sel_hi:[1,0]
    v_pk_mul_f32 v[36:37], v[36:37], v[42:43] op_sel_hi:[1,0]
    v_pk_mul_f32 v[38:39], v[38:39], v[42:43] op_sel_hi:[1,0]
    v_cvt_pk_bf16_f32 v16, v32, v33
    v_cvt_pk_bf16_f32 v17, v34, v35
    v_cvt_pk_bf16_f32 v18, v36, v37
    v_cvt_pk_bf16_f32 v19, v38, v39
    v_and_b32 v16, v16, v3
    v_and_b32 v17, v17, v3
    v_and_b32 v18, v18, v3
    v_and_b32 v19, v19, v3
    ds_write_b128 v4, v[16:19] offset:32128
    s_waitcnt lgkmcnt(0)
    ds_read_b128 v[128:131], v5 offset:32128
    ds_read_b128 v[132:135], v5 offset:32192
    ds_read_b128 v[136:139], v5 offset:32256
    ds_read_b128 v[140:143], v5 offset:32320
    ds_read_b128 v[144:147], v5 offset:32384
    ds_read_b128 v[148:151], v5 offset:32448
    ds_read_b128 v[152:155], v5 offset:32512
    ds_read_b128 v[156:159], v5 offset:32576
    ds_read_b128 v[160:163], v5 offset:32640
    ds_read_b128 v[164:167], v5 offset:32704
    ds_read_b128 v[168:171], v5 offset:32768
    ds_read_b128 v[172:175], v5 offset:32832
    ds_read_b128 v[176:179], v5 offset:32896
    ds_read_b128 v[180:183], v5 offset:32960
    s_waitcnt lgkmcnt(13)
    v_mfma_f32_16x16x32_bf16 v[48:51], v[128:131], v[64:67], 0
    s_waitcnt lgkmcnt(12)
    v_mfma_f32_16x16x32_bf16 v[48:51], v[132:135], v[68:71], v[48:51]
    s_waitcnt lgkmcnt(11)
    v_mfma_f32_16x16x32_bf16 v[48:51], v[136:139], v[72:75], v[48:51]
    s_waitcnt lgkmcnt(10)
    v_mfma_f32_16x16x32_bf16 v[48:51], v[140:143], v[76:79], v[48:51]
    s_waitcnt lgkmcnt(9)
    v_mfma_f32_16x16x32_bf16 v[48:51], v[144:147], v[80:83], v[48:51]
    s_waitcnt lgkmcnt(8)
    v_mfma_f32_16x16x32_bf16 v[48:51], v[148:151], v[84:87], v[48:51]
    s_waitcnt lgkmcnt(7)
    v_mfma_f32_16x16x32_bf16 v[48:51], v[152:155], v[88:91], v[48:51]
    s_waitcnt lgkmcnt(6)
    v_mfma_f32_16x16x32_bf16 v[48:51], v[156:159], v[92:95], v[48:51]
    s_waitcnt lgkmcnt(5)
    v_mfma_f32_16x16x32_bf16 v[48:51], v[160:163], v[96:99], v[48:51]
    s_waitcnt lgkmcnt(4)
    v_mfma_f32_16x16x32_bf16 v[48:51], v[164:167], v[100:103], v[48:51]
    s_waitcnt lgkmcnt(3)
    v_mfma_f32_16x16x32_bf16 v[48:51], v[168:171], v[104:107], v[48:51]
    s_waitcnt lgkmcnt(2)
    v_mfma_f32_16x16x32_bf16 v[48:51], v[172:175], v[108:111], v[48:51]
    s_waitcnt lgkmcnt(1)
    v_mfma_f32_16x16x32_bf16 v[48:51], v[176:179], v[112:115], v[48:51]
    s_waitcnt lgkmcnt(0)
    v_mfma_f32_16x16x32_bf16 v[48:51], v[180:183], v[116:119], v[48:51]
    s_nop 7
    s_nop 1
    v_cvt_pk_bf16_f32 v40, v48, v48
    v_and_b32 v40, 0xffff0000, v40
    v_add_f32 v40, v40, v12
    v_cvt_pk_bf16_f32 v40, v40, v40
    v_and_b32 v40, 0xffff0000, v40
    v_mul_f32 v41, v40, v40
    v_mov_b32 v42, 0xc0135761
    v_fmac_f32 v42, 0xbdd2d3e8, v41
    v_mul_f32 v42, v42, v40
    v_exp_f32 v42, v42
    s_add_u32 s52, s93, s81
    v_add_f32 v42, 1.0, v42
    v_rcp_f32 v42, v42
    s_nop 0
    v_mul_f32 v43, v40, v42
    s_nop 1
    v_mov_b32_dpp v44, v43 quad_perm:[1,0,3,2] row_mask:0xf bank_mask:0xf
    s_nop 0
    v_cvt_pk_bf16_f32 v44, v43, v44
    s_nop 0
    v_readlane_b32 s72, v44, 0
    v_readlane_b32 s73, v44, 2
    v_readlane_b32 s74, v44, 4
    v_readlane_b32 s75, v44, 6
    s_nop 1
    v_dot2_f32_bf16 v48, v192, s72, 0
    v_dot2_f32_bf16 v49, v193, s72, 0
    v_dot2_f32_bf16 v50, v194, s72, 0
    v_dot2_f32_bf16 v51, v195, s72, 0
    v_dot2_f32_bf16 v52, v196, s72, 0
    v_dot2_f32_bf16 v53, v197, s72, 0
    v_dot2_f32_bf16 v54, v198, s72, 0
    v_dot2_f32_bf16 v55, v199, s72, 0
    v_dot2_f32_bf16 v48, v200, s73, v48
    v_dot2_f32_bf16 v49, v201, s73, v49
    v_dot2_f32_bf16 v50, v202, s73, v50
    v_dot2_f32_bf16 v51, v203, s73, v51
    v_dot2_f32_bf16 v52, v204, s73, v52
    v_dot2_f32_bf16 v53, v205, s73, v53
    v_dot2_f32_bf16 v54, v206, s73, v54
    v_dot2_f32_bf16 v55, v207, s73, v55
    v_dot2_f32_bf16 v48, v208, s74, v48
    v_dot2_f32_bf16 v49, v209, s74, v49
    v_dot2_f32_bf16 v50, v210, s74, v50
    v_dot2_f32_bf16 v51, v211, s74, v51
    v_dot2_f32_bf16 v52, v212, s74, v52
    v_dot2_f32_bf16 v53, v213, s74, v53
    v_dot2_f32_bf16 v54, v214, s74, v54
    v_dot2_f32_bf16 v55, v215, s74, v55
    v_dot2_f32_bf16 v48, v216, s75, v48
    v_dot2_f32_bf16 v49, v217, s75, v49
    v_dot2_f32_bf16 v50, v218, s75, v50
    v_dot2_f32_bf16 v51, v219, s75, v51
    v_dot2_f32_bf16 v52, v220, s75, v52
    v_dot2_f32_bf16 v53, v221, s75, v53
    v_dot2_f32_bf16 v54, v222, s75, v54
    v_dot2_f32_bf16 v55, v223, s75, v55
    s_nop 2
    s_cmp_ge_u32 s3, 28
    s_cbranch_scc1 L_G1skipst
    s_mov_b32 exec_lo, -1
    s_mov_b32 exec_hi, 0xffffff
    buffer_store_dwordx4 v[48:51], v10, s[32:35], s52 offen sc1
    buffer_store_dwordx4 v[52:55], v11, s[32:35], s52 offen sc1
    s_mov_b64 exec, -1
L_G1skipst:
    s_barrier
    s_cmp_lg_u32 s81, 0x8000
    s_cbranch_scc1 L_G1end
    s_barrier
    s_barrier
    s_barrier
    s_barrier
    s_barrier
    s_barrier
    s_barrier
    s_add_u32 s81, s81, 0x164000
    s_branch L_G1loop
L_G1end:
    s_endpgm
L_G2:
    v_mov_b32 v24, 0
    v_mov_b32 v25, 0
    v_mov_b32 v26, 0
    v_mov_b32 v27, 0
    s_mov_b32 exec_lo, 0xffffffff
    s_mov_b32 exec_hi, 0
    ds_write_b128 v4, v[24:27] offset:1024
    s_mov_b32 exec_lo, 0xffff
    s_mov_b32 exec_hi, 0
    ds_write_b128 v4, v[24:27] offset:2048
    s_mov_b32 exec_lo, 0x1
    s_mov_b32 exec_hi, 0
    ds_write_b32 v8, v24 offset:2368
    s_mov_b64 exec, -1
    s_waitcnt lgkmcnt(0)
    s_mov_b32 s52, 0x4000
    buffer_load_dword v62, v8, s[32:35], s52 offen sc1
    s_barrier
    s_waitcnt vmcnt(0)
    v_readfirstlane_b32 s94, v62
    s_add_u32 s94, s94, 0x9e3779b9
    s_sleep 64
    s_sleep 46
    s_lshl_b32 s60, s31, 11
    v_lshlrev_b32 v41, 5, v1
    s_mov_b32 s80, 0
L_q0poll:
    buffer_load_dwordx4 v[48:51], v41, s[32:35], s60 offen sc1
    buffer_load_dwordx4 v[52:55], v41, s[32:35], s60 offen offset:16 sc1
    s_waitcnt vmcnt(0)
    v_xor_b32 v49, s94, v49
    v_xor_b32 v51, s94, v51
    v_xor_b32 v53, s94, v53
    v_xor_b32 v55, s94, v55
    v_or3_b32 v49, v49, v51, v53
    v_or_b32 v49, v49, v55
    v_cmp_ne_u32 vcc, 0, v49
    s_add_u32 s80, s80, 1
    s_cbranch_vccz L_q0done
    s_sleep 8
    s_cmp_lt_u32 s80, 0x100000
    s_cbranch_scc1 L_q0poll
L_q0done:
    v_mov_b32 v24, v48
    v_mov_b32 v25, v50
    v_mov_b32 v26, v52
    v_mov_b32 v27, v54
    ds_write_b128 v4, v[24:27] offset:0
    s_waitcnt lgkmcnt(0)
    s_barrier
    s_setprio 0
    s_lshl_b32 s87, s31, 9
    s_lshl_b32 s53, s3, 4
    s_add_u32 s87, s87, s53
    s_mul_i32 s52, s87, 896
    s_add_u32 s44, s12, s52
    s_addc_u32 s45, s13, 0
    s_and_b32 s45, s45, 0xffff
    s_mov_b32 s46, 0x3800
    s_mov_b32 s47, 0x00020000
    s_mov_b32 s53, 0
    s_mov_b32 s54, 3584
    s_mov_b32 s55, 7168
    s_mov_b32 s56, 10752
    s_mov_b32 exec_lo, -1
    s_mov_b32 exec_hi, 0xffffff
    buffer_load_dwordx4 v[128:131], v4, s[44:47], s53 offen offset:0 nt
    buffer_load_dwordx4 v[132:135], v4, s[44:47], s53 offen offset:896 nt
    buffer_load_dwordx4 v[136:139], v4, s[44:47], s53 offen offset:1792 nt
    buffer_load_dwordx4 v[140:143], v4, s[44:47], s53 offen offset:2688 nt
    buffer_load_dwordx4 v[144:147], v4, s[44:47], s54 offen offset:0 nt
    buffer_load_dwordx4 v[148:151], v4, s[44:47], s54 offen offset:896 nt
    buffer_load_dwordx4 v[152:155], v4, s[44:47], s54 offen offset:1792 nt
    buffer_load_dwordx4 v[156:159], v4, s[44:47], s54 offen offset:2688 nt
    buffer_load_dwordx4 v[160:163], v4, s[44:47], s55 offen offset:0 nt
    buffer_load_dwordx4 v[164:167], v4, s[44:47], s55 offen offset:896 nt
    buffer_load_dwordx4 v[168:171], v4, s[44:47], s55 offen offset:1792 nt
    buffer_load_dwordx4 v[172:175], v4, s[44:47], s55 offen offset:2688 nt
    buffer_load_dwordx4 v[176:179], v4, s[44:47], s56 offen offset:0 nt
    buffer_load_dwordx4 v[180:183], v4, s[44:47], s56 offen offset:896 nt
    buffer_load_dwordx4 v[184:187], v4, s[44:47], s56 offen offset:1792 nt
    buffer_load_dwordx4 v[188:191], v4, s[44:47], s56 offen offset:2688 nt
    s_mov_b64 exec, -1
    s_setprio 3
    s_barrier
    v_lshlrev_b32 v10, 13, v1
    v_add_u32 v11, 4096, v10
    s_lshl_b32 s87, s2, 4
    s_add_u32 s87, s87, 0x80000
    s_lshl_b32 s92, s31, 16
    s_lshl_b32 s53, s3, 11
    s_add_u32 s92, s92, s53
    s_lshl_b32 s93, s31, 9
    s_lshr_b32 s53, s3, 4
    s_lshl_b32 s53, s53, 8
    s_add_u32 s93, s93, s53
    s_add_u32 s93, s93, 0x160000
    v_and_b32 v40, 31, v1
    v_lshrrev_b32 v41, 5, v1
    v_lshlrev_b32 v13, 6, v40
    v_lshl_add_u32 v13, v41, 5, v13
    v_lshlrev_b32 v14, 3, v40
    s_waitcnt vmcnt(0)
    v_perm_b32 v192, v132, v128, s82
    v_perm_b32 v193, v132, v128, s83
    v_perm_b32 v194, v133, v129, s82
    v_perm_b32 v195, v133, v129, s83
    v_perm_b32 v196, v134, v130, s82
    v_perm_b32 v197, v134, v130, s83
    v_perm_b32 v198, v135, v131, s82
    v_perm_b32 v199, v135, v131, s83
    v_perm_b32 v200, v140, v136, s82
    v_perm_b32 v201, v140, v136, s83
    v_perm_b32 v202, v141, v137, s82
    v_perm_b32 v203, v141, v137, s83
    v_perm_b32 v204, v142, v138, s82
    v_perm_b32 v205, v142, v138, s83
    v_perm_b32 v206, v143, v139, s82
    v_perm_b32 v207, v143, v139, s83
    v_perm_b32 v208, v148, v144, s82
    v_perm_b32 v209, v148, v144, s83
    v_perm_b32 v210, v149, v145, s82
    v_perm_b32 v211, v149, v145, s83
    v_perm_b32 v212, v150, v146, s82
    v_perm_b32 v213, v150, v146, s83
    v_perm_b32 v214, v151, v147, s82
    v_perm_b32 v215, v151, v147, s83
    v_perm_b32 v216, v156, v152, s82
    v_perm_b32 v217, v156, v152, s83
    v_perm_b32 v218, v157, v153, s82
    v_perm_b32 v219, v157, v153, s83
    v_perm_b32 v220, v158, v154, s82
    v_perm_b32 v221, v158, v154, s83
    v_perm_b32 v222, v159, v155, s82
    v_perm_b32 v223, v159, v155, s83
    v_perm_b32 v224, v164, v160, s82
    v_perm_b32 v225, v164, v160, s83
    v_perm_b32 v226, v165, v161, s82
    v_perm_b32 v227, v165, v161, s83
    v_perm_b32 v228, v166, v162, s82
    v_perm_b32 v229, v166, v162, s83
    v_perm_b32 v230, v167, v163, s82
    v_perm_b32 v231, v167, v163, s83
    v_perm_b32 v232, v172, v168, s82
    v_perm_b32 v233, v172, v168, s83
    v_perm_b32 v234, v173, v169, s82
    v_perm_b32 v235, v173, v169, s83
    v_perm_b32 v236, v174, v170, s82
    v_perm_b32 v237, v174, v170, s83
    v_perm_b32 v238, v175, v171, s82
    v_perm_b32 v239, v175, v171, s83
    v_perm_b32 v240, v180, v176, s82
    v_perm_b32 v241, v180, v176, s83
    v_perm_b32 v242, v181, v177, s82
    v_perm_b32 v243, v181, v177, s83
    v_perm_b32 v244, v182, v178, s82
    v_perm_b32 v245, v182, v178, s83
    v_perm_b32 v246, v183, v179, s82
    v_perm_b32 v247, v183, v179, s83
    v_perm_b32 v248, v188, v184, s82
    v_perm_b32 v249, v188, v184, s83
    v_perm_b32 v250, v189, v185, s82
    v_perm_b32 v251, v189, v185, s83
    v_perm_b32 v252, v190, v186, s82
    v_perm_b32 v253, v190, v186, s83
    v_perm_b32 v254, v191, v187, s82
    v_perm_b32 v255, v191, v187, s83
L_G2loop:
    s_barrier
    s_barrier
L_G2mid:
    s_add_u32 s60, s92, s81
    s_add_u32 s61, s93, s81
    s_sleep 14
    s_mov_b32 s80, 0
Lpoll_5:
    buffer_load_dwordx4 v[48:51], v13, s[32:35], s60 offen offset:0 sc1
    buffer_load_dwordx4 v[52:55], v13, s[32:35], s60 offen offset:16 sc1
    buffer_load_dwordx2 v[56:57], v14, s[32:35], s61 offen offset:0 sc1
    s_waitcnt vmcnt(0)
    v_max3_u32 v40, v48, v49, v50
    v_max3_u32 v40, v40, v51, v52
    v_max3_u32 v40, v40, v53, v54
    v_max3_u32 v40, v40, v55, v56
    v_max_u32 v40, v40, v57
    v_cmp_eq_u32 vcc, -1, v40
    s_add_u32 s80, s80, 1
    s_cbranch_vccz Lpolld_6
    s_sleep 1
    s_cmp_lg_u32 s81, 0x8000
    s_cbranch_scc1 Lr_7
    s_sleep 1
Lr_7:
    s_cmp_lt_u32 s80, 0x100000
    s_cbranch_scc1 Lpoll_5
Lpolld_6:
    v_mov_b32 v58, v56
    s_nop 1
    v_max_f32_dpp v58, v58, v58 row_ror:8 row_mask:0xf bank_mask:0xf
    s_nop 1
    v_max_f32_dpp v58, v58, v58 row_ror:4 row_mask:0xf bank_mask:0xf
    s_nop 1
    v_max_f32_dpp v58, v58, v58 row_ror:2 row_mask:0xf bank_mask:0xf
    s_nop 1
    v_max_f32_dpp v58, v58, v58 row_ror:1 row_mask:0xf bank_mask:0xf
    s_nop 1
    v_max_f32_dpp v58, v58, v58 row_bcast:15 row_mask:0xa bank_mask:0xf
    s_nop 1
    v_max_f32_dpp v58, v58, v58 row_bcast:31 row_mask:0xc bank_mask:0xf
    s_nop 1
    v_readlane_b32 s52, v58, 63
    s_nop 1
    v_subrev_f32 v58, s52, v56
    v_mul_f32 v58, 0x3fb8aa3b, v58
    v_exp_f32 v58, v58
    s_nop 0
    v_pk_mul_f32 v[48:49], v[48:49], v[58:59] op_sel_hi:[1,0]
    v_pk_mul_f32 v[50:51], v[50:51], v[58:59] op_sel_hi:[1,0]
    v_pk_mul_f32 v[52:53], v[52:53], v[58:59] op_sel_hi:[1,0]
    v_pk_mul_f32 v[54:55], v[54:55], v[58:59] op_sel_hi:[1,0]
    v_mul_f32 v57, v57, v58
    s_nop 1
    v_add_f32_dpp v48, v48, v48 row_ror:8 row_mask:0xf bank_mask:0xf
    v_add_f32_dpp v49, v49, v49 row_ror:8 row_mask:0xf bank_mask:0xf
    v_add_f32_dpp v50, v50, v50 row_ror:8 row_mask:0xf bank_mask:0xf
    v_add_f32_dpp v51, v51, v51 row_ror:8 row_mask:0xf bank_mask:0xf
    v_add_f32_dpp v52, v52, v52 row_ror:8 row_mask:0xf bank_mask:0xf
    v_add_f32_dpp v53, v53, v53 row_ror:8 row_mask:0xf bank_mask:0xf
    v_add_f32_dpp v54, v54, v54 row_ror:8 row_mask:0xf bank_mask:0xf
    v_add_f32_dpp v55, v55, v55 row_ror:8 row_mask:0xf bank_mask:0xf
    v_add_f32_dpp v57, v57, v57 row_ror:8 row_mask:0xf bank_mask:0xf
    v_add_f32_dpp v48, v48, v48 row_ror:4 row_mask:0xf bank_mask:0xf
    v_add_f32_dpp v49, v49, v49 row_ror:4 row_mask:0xf bank_mask:0xf
    v_add_f32_dpp v50, v50, v50 row_ror:4 row_mask:0xf bank_mask:0xf
    v_add_f32_dpp v51, v51, v51 row_ror:4 row_mask:0xf bank_mask:0xf
    v_add_f32_dpp v52, v52, v52 row_ror:4 row_mask:0xf bank_mask:0xf
    v_add_f32_dpp v53, v53, v53 row_ror:4 row_mask:0xf bank_mask:0xf
    v_add_f32_dpp v54, v54, v54 row_ror:4 row_mask:0xf bank_mask:0xf
    v_add_f32_dpp v55, v55, v55 row_ror:4 row_mask:0xf bank_mask:0xf
    v_add_f32_dpp v57, v57, v57 row_ror:4 row_mask:0xf bank_mask:0xf
    v_add_f32_dpp v48, v48, v48 row_ror:2 row_mask:0xf bank_mask:0xf
    v_add_f32_dpp v49, v49, v49 row_ror:2 row_mask:0xf bank_mask:0xf
    v_add_f32_dpp v50, v50, v50 row_ror:2 row_mask:0xf bank_mask:0xf
    v_add_f32_dpp v51, v51, v51 row_ror:2 row_mask:0xf bank_mask:0xf
    v_add_f32_dpp v52, v52, v52 row_ror:2 row_mask:0xf bank_mask:0xf
    v_add_f32_dpp v53, v53, v53 row_ror:2 row_mask:0xf bank_mask:0xf
    v_add_f32_dpp v54, v54, v54 row_ror:2 row_mask:0xf bank_mask:0xf
    v_add_f32_dpp v55, v55, v55 row_ror:2 row_mask:0xf bank_mask:0xf
    v_add_f32_dpp v57, v57, v57 row_ror:2 row_mask:0xf bank_mask:0xf
    v_add_f32_dpp v48, v48, v48 row_ror:1 row_mask:0xf bank_mask:0xf
    v_add_f32_dpp v49, v49, v49 row_ror:1 row_mask:0xf bank_mask:0xf
    v_add_f32_dpp v50, v50, v50 row_ror:1 row_mask:0xf bank_mask:0xf
    v_add_f32_dpp v51, v51, v51 row_ror:1 row_mask:0xf bank_mask:0xf
    v_add_f32_dpp v52, v52, v52 row_ror:1 row_mask:0xf bank_mask:0xf
    v_add_f32_dpp v53, v53, v53 row_ror:1 row_mask:0xf bank_mask:0xf
    v_add_f32_dpp v54, v54, v54 row_ror:1 row_mask:0xf bank_mask:0xf
    v_add_f32_dpp v55, v55, v55 row_ror:1 row_mask:0xf bank_mask:0xf
    v_add_f32_dpp v57, v57, v57 row_ror:1 row_mask:0xf bank_mask:0xf
    v_add_f32_dpp v48, v48, v48 row_bcast:15 row_mask:0xa bank_mask:0xf
    v_add_f32_dpp v49, v49, v49 row_bcast:15 row_mask:0xa bank_mask:0xf
    v_add_f32_dpp v50, v50, v50 row_bcast:15 row_mask:0xa bank_mask:0xf
    v_add_f32_dpp v51, v51, v51 row_bcast:15 row_mask:0xa bank_mask:0xf
    v_add_f32_dpp v52, v52, v52 row_bcast:15 row_mask:0xa bank_mask:0xf
    v_add_f32_dpp v53, v53, v53 row_bcast:15 row_mask:0xa bank_mask:0xf
    v_add_f32_dpp v54, v54, v54 row_bcast:15 row_mask:0xa bank_mask:0xf
    v_add_f32_dpp v55, v55, v55 row_bcast:15 row_mask:0xa bank_mask:0xf
    v_add_f32_dpp v57, v57, v57 row_bcast:15 row_mask:0xa bank_mask:0xf
    s_add_u32 s52, s87, s81
    v_rcp_f32 v58, v57
    s_nop 0
    v_pk_mul_f32 v[48:49], v[48:49], v[58:59] op_sel_hi:[1,0]
    v_pk_mul_f32 v[50:51], v[50:51], v[58:59] op_sel_hi:[1,0]
    v_pk_mul_f32 v[52:53], v[52:53], v[58:59] op_sel_hi:[1,0]
    v_pk_mul_f32 v[54:55], v[54:55], v[58:59] op_sel_hi:[1,0]
    v_cvt_pk_bf16_f32 v40, v48, v49
    v_cvt_pk_bf16_f32 v41, v50, v51
    v_cvt_pk_bf16_f32 v42, v52, v53
    v_cvt_pk_bf16_f32 v43, v54, v55
    s_nop 0
    v_readlane_b32 s72, v40, 31
    v_readlane_b32 s76, v40, 63
    v_readlane_b32 s73, v41, 31
    v_readlane_b32 s77, v41, 63
    v_readlane_b32 s74, v42, 31
    v_readlane_b32 s78, v42, 63
    v_readlane_b32 s75, v43, 31
    v_readlane_b32 s79, v43, 63
    s_nop 1
    v_dot2_f32_bf16 v48, v192, s72, 0
    v_dot2_f32_bf16 v49, v193, s72, 0
    v_dot2_f32_bf16 v50, v194, s72, 0
    v_dot2_f32_bf16 v51, v195, s72, 0
    v_dot2_f32_bf16 v52, v196, s72, 0
    v_dot2_f32_bf16 v53, v197, s72, 0
    v_dot2_f32_bf16 v54, v198, s72, 0
    v_dot2_f32_bf16 v55, v199, s72, 0
    v_dot2_f32_bf16 v48, v200, s73, v48
    v_dot2_f32_bf16 v49, v201, s73, v49
    v_dot2_f32_bf16 v50, v202, s73, v50
    v_dot2_f32_bf16 v51, v203, s73, v51
    v_dot2_f32_bf16 v52, v204, s73, v52
    v_dot2_f32_bf16 v53, v205, s73, v53
    v_dot2_f32_bf16 v54, v206, s73, v54
    v_dot2_f32_bf16 v55, v207, s73, v55
    v_dot2_f32_bf16 v48, v208, s74, v48
    v_dot2_f32_bf16 v49, v209, s74, v49
    v_dot2_f32_bf16 v50, v210, s74, v50
    v_dot2_f32_bf16 v51, v211, s74, v51
    v_dot2_f32_bf16 v52, v212, s74, v52
    v_dot2_f32_bf16 v53, v213, s74, v53
    v_dot2_f32_bf16 v54, v214, s74, v54
    v_dot2_f32_bf16 v55, v215, s74, v55
    v_dot2_f32_bf16 v48, v216, s75, v48
    v_dot2_f32_bf16 v49, v217, s75, v49
    v_dot2_f32_bf16 v50, v218, s75, v50
    v_dot2_f32_bf16 v51, v219, s75, v51
    v_dot2_f32_bf16 v52, v220, s75, v52
    v_dot2_f32_bf16 v53, v221, s75, v53
    v_dot2_f32_bf16 v54, v222, s75, v54
    v_dot2_f32_bf16 v55, v223, s75, v55
    v_dot2_f32_bf16 v48, v224, s76, v48
    v_dot2_f32_bf16 v49, v225, s76, v49
    v_dot2_f32_bf16 v50, v226, s76, v50
    v_dot2_f32_bf16 v51, v227, s76, v51
    v_dot2_f32_bf16 v52, v228, s76, v52
    v_dot2_f32_bf16 v53, v229, s76, v53
    v_dot2_f32_bf16 v54, v230, s76, v54
    v_dot2_f32_bf16 v55, v231, s76, v55
    v_dot2_f32_bf16 v48, v232, s77, v48
    v_dot2_f32_bf16 v49, v233, s77, v49
    v_dot2_f32_bf16 v50, v234, s77, v50
    v_dot2_f32_bf16 v51, v235, s77, v51
    v_dot2_f32_bf16 v52, v236, s77, v52
    v_dot2_f32_bf16 v53, v237, s77, v53
    v_dot2_f32_bf16 v54, v238, s77, v54
    v_dot2_f32_bf16 v55, v239, s77, v55
    v_dot2_f32_bf16 v48, v240, s78, v48
    v_dot2_f32_bf16 v49, v241, s78, v49
    v_dot2_f32_bf16 v50, v242, s78, v50
    v_dot2_f32_bf16 v51, v243, s78, v51
    v_dot2_f32_bf16 v52, v244, s78, v52
    v_dot2_f32_bf16 v53, v245, s78, v53
    v_dot2_f32_bf16 v54, v246, s78, v54
    v_dot2_f32_bf16 v55, v247, s78, v55
    v_dot2_f32_bf16 v48, v248, s79, v48
    v_dot2_f32_bf16 v49, v249, s79, v49
    v_dot2_f32_bf16 v50, v250, s79, v50
    v_dot2_f32_bf16 v51, v251, s79, v51
    v_dot2_f32_bf16 v52, v252, s79, v52
    v_dot2_f32_bf16 v53, v253, s79, v53
    v_dot2_f32_bf16 v54, v254, s79, v54
    v_dot2_f32_bf16 v55, v255, s79, v55
    s_nop 2
    s_mov_b32 exec_lo, -1
    s_mov_b32 exec_hi, 0xffffff
    buffer_store_dwordx4 v[48:51], v10, s[32:35], s52 offen sc1
    buffer_store_dwordx4 v[52:55], v11, s[32:35], s52 offen sc1
    s_mov_b64 exec, -1
    s_barrier
    s_cmp_lg_u32 s81, 0x8000
    s_cbranch_scc1 L_G2end
    s_barrier
    s_barrier
    s_barrier
    s_barrier
    s_lshl_b32 s60, s31, 10
    s_add_u32 s60, s60, 0x16a000
    s_sleep 14
    s_mov_b32 s80, 0
Lpoll_8:
    buffer_load_dwordx4 v[24:27], v4, s[32:35], s60 offen offset:0 sc1
    s_waitcnt vmcnt(0)
    v_max3_u32 v40, v24, v25, v26
    v_max_u32 v40, v40, v27
    v_cmp_eq_u32 vcc, -1, v40
    s_add_u32 s80, s80, 1
    s_cbranch_vccz Lpolld_9
    s_sleep 1
    s_cmp_lt_u32 s80, 0x100000
    s_cbranch_scc1 Lpoll_8
Lpolld_9:
    ds_write_b128 v4, v[24:27] offset:0
    s_waitcnt lgkmcnt(0)
    s_barrier
    s_barrier
    s_add_u32 s81, s81, 0x164000
    s_branch L_G2loop
L_G2end:
    s_endpgm
L_G3:
    s_mul_i32 s52, s2, 6144
    s_add_u32 s52, s52, 0x8000
    s_add_u32 s53, s52, 4096
    s_add_u32 s54, s52, 8192
    v_mov_b32 v24, -1
    v_mov_b32 v25, -1
    v_mov_b32 v26, -1
    v_mov_b32 v27, -1
    buffer_store_dwordx4 v[24:27], v4, s[32:35], s52 offen offset:0 sc1
    buffer_store_dwordx4 v[24:27], v4, s[32:35], s52 offen offset:1024 sc1
    buffer_store_dwordx4 v[24:27], v4, s[32:35], s52 offen offset:2048 sc1
    buffer_store_dwordx4 v[24:27], v4, s[32:35], s52 offen offset:3072 sc1
    buffer_store_dwordx4 v[24:27], v4, s[32:35], s53 offen offset:0 sc1
    buffer_store_dwordx4 v[24:27], v4, s[32:35], s53 offen offset:1024 sc1
    s_mov_b32 s52, 0x4000
    buffer_load_dword v62, v8, s[32:35], s52 offen sc1
    s_mul_i32 s87, s31, 14
    s_add_u32 s87, s87, s100
    s_lshl_b32 s92, s87, 3
    s_lshl_b32 s87, s87, 12
    s_mov_b32 s36, s4
    s_and_b32 s37, s5, 0xffff
    s_mov_b32 s38, 0x380
    s_mov_b32 s39, 0x00020000
    s_mov_b32 s40, s22
    s_and_b32 s41, s23, 0xffff
    s_mov_b32 s42, 0x380
    s_mov_b32 s43, 0x00020000
    buffer_load_dwordx2 v[40:41], v8, s[36:39], s92 offen
    buffer_load_dwordx2 v[42:43], v8, s[40:43], s92 offen
    s_barrier
    s_waitcnt vmcnt(0)
    v_readfirstlane_b32 s94, v62
    s_add_u32 s94, s94, 0x9e3779b9
    s_lshl_b32 s52, s2, 3
    s_add_u32 s52, s52, 0x5000
    v_mov_b32 v44, s94
    v_mov_b32 v45, s94
    s_mov_b32 exec_lo, 0x1
    s_mov_b32 exec_hi, 0
    buffer_store_dwordx2 v[44:45], v8, s[32:35], s52 offen sc1
    s_mov_b64 exec, -1
    v_lshlrev_b32 v16, 16, v40
    v_and_b32 v17, 0xffff0000, v40
    v_lshlrev_b32 v20, 16, v42
    v_and_b32 v21, 0xffff0000, v42
    v_lshlrev_b32 v18, 16, v41
    v_and_b32 v19, 0xffff0000, v41
    v_lshlrev_b32 v22, 16, v43
    v_and_b32 v23, 0xffff0000, v43
    s_mov_b32 s36, s24
    s_and_b32 s37, s25, 0xffff
    s_mov_b32 s38, 0x380
    s_mov_b32 s39, 0x00020000
    v_min_u32 v10, 31, v1
    v_lshlrev_b32 v10, 4, v10
    v_cmp_gt_u32 vcc, 32, v1
    s_nop 1
    v_cndmask_b32 v12, 0, 1.0, vcc
    s_barrier
    s_barrier
L_G3loop:
    s_barrier
    s_barrier
    s_barrier
    s_add_u32 s60, s87, s81
    s_add_u32 s60, s60, 0x80000
    s_sleep 20
    s_mov_b32 s80, 0
Lpoll_10:
    buffer_load_dwordx4 v[64:67], v4, s[32:35], s60 offen offset:0 sc1
    buffer_load_dwordx4 v[68:71], v4, s[32:35], s60 offen offset:1024 sc1
    buffer_load_dwordx4 v[72:75], v4, s[32:35], s60 offen offset:2048 sc1
    buffer_load_dwordx4 v[76:79], v4, s[32:35], s60 offen offset:3072 sc1
    s_waitcnt vmcnt(0)
    v_max3_u32 v40, v64, v65, v66
    v_max3_u32 v40, v40, v67, v68
    v_max3_u32 v40, v40, v69, v70
    v_max3_u32 v40, v40, v71, v72
    v_max3_u32 v40, v40, v73, v74
    v_max3_u32 v40, v40, v75, v76
    v_max3_u32 v40, v40, v77, v78
    v_max_u32 v40, v40, v79
    v_cmp_eq_u32 vcc, -1, v40
    s_add_u32 s80, s80, 1
    s_cbranch_vccz Lpolld_11
    s_sleep 1
    s_cmp_lg_u32 s81, 0x8000
    s_cbranch_scc1 Lr_12
    s_sleep 1
Lr_12:
    s_cmp_lt_u32 s80, 0x100000
    s_cbranch_scc1 Lpoll_10
Lpolld_11:
    v_pk_add_f32 v[64:65], v[64:65], v[68:69]
    v_pk_add_f32 v[72:73], v[72:73], v[76:77]
    v_pk_add_f32 v[66:67], v[66:67], v[70:71]
    v_pk_add_f32 v[74:75], v[74:75], v[78:79]
    v_pk_add_f32 v[64:65], v[64:65], v[72:73]
    v_pk_add_f32 v[66:67], v[66:67], v[74:75]
    s_add_u32 s52, s92, s81
    s_add_u32 s52, s52, 0x161000
    v_add_f32_dpp v64, v64, v64 row_ror:8 row_mask:0xf bank_mask:0xf
    v_add_f32_dpp v65, v65, v65 row_ror:8 row_mask:0xf bank_mask:0xf
    v_add_f32_dpp v66, v66, v66 row_ror:8 row_mask:0xf bank_mask:0xf
    v_add_f32_dpp v67, v67, v67 row_ror:8 row_mask:0xf bank_mask:0xf
    v_add_f32_dpp v64, v64, v64 row_ror:4 row_mask:0xf bank_mask:0xf
    v_add_f32_dpp v65, v65, v65 row_ror:4 row_mask:0xf bank_mask:0xf
    v_add_f32_dpp v66, v66, v66 row_ror:4 row_mask:0xf bank_mask:0xf
    v_add_f32_dpp v67, v67, v67 row_ror:4 row_mask:0xf bank_mask:0xf
    v_add_f32_dpp v64, v64, v64 row_ror:2 row_mask:0xf bank_mask:0xf
    v_add_f32_dpp v65, v65, v65 row_ror:2 row_mask:0xf bank_mask:0xf
    v_add_f32_dpp v66, v66, v66 row_ror:2 row_mask:0xf bank_mask:0xf
    v_add_f32_dpp v67, v67, v67 row_ror:2 row_mask:0xf bank_mask:0xf
    v_add_f32_dpp v64, v64, v64 row_ror:1 row_mask:0xf bank_mask:0xf
    v_add_f32_dpp v65, v65, v65 row_ror:1 row_mask:0xf bank_mask:0xf
    v_add_f32_dpp v66, v66, v66 row_ror:1 row_mask:0xf bank_mask:0xf
    v_add_f32_dpp v67, v67, v67 row_ror:1 row_mask:0xf bank_mask:0xf
    v_add_f32_dpp v64, v64, v64 row_bcast:15 row_mask:0xa bank_mask:0xf
    v_add_f32_dpp v65, v65, v65 row_bcast:15 row_mask:0xa bank_mask:0xf
    v_add_f32_dpp v66, v66, v66 row_bcast:15 row_mask:0xa bank_mask:0xf
    v_add_f32_dpp v67, v67, v67 row_bcast:15 row_mask:0xa bank_mask:0xf
    v_add_f32_dpp v64, v64, v64 row_bcast:31 row_mask:0xc bank_mask:0xf
    v_add_f32_dpp v65, v65, v65 row_bcast:31 row_mask:0xc bank_mask:0xf
    v_add_f32_dpp v66, v66, v66 row_bcast:31 row_mask:0xc bank_mask:0xf
    v_add_f32_dpp v67, v67, v67 row_bcast:31 row_mask:0xc bank_mask:0xf
    v_cvt_pk_bf16_f32 v40, v64, v65
    v_cvt_pk_bf16_f32 v41, v66, v67
    v_lshlrev_b32 v64, 16, v40
    v_and_b32 v65, 0xffff0000, v40
    v_lshlrev_b32 v66, 16, v41
    v_and_b32 v67, 0xffff0000, v41
    v_pk_add_f32 v[16:17], v[16:17], v[64:65]
    v_pk_add_f32 v[18:19], v[18:19], v[66:67]
    v_cvt_pk_bf16_f32 v40, v16, v17
    v_cvt_pk_bf16_f32 v41, v18, v19
    v_lshlrev_b32 v16, 16, v40
    v_and_b32 v17, 0xffff0000, v40
    v_lshlrev_b32 v18, 16, v41
    v_and_b32 v19, 0xffff0000, v41
    s_cmp_ge_u32 s3, 14
    s_cbranch_scc1 L_G3skipx1
    s_mov_b32 exec_lo, 0
    s_mov_b32 exec_hi, 0x80000000
    buffer_store_dwordx2 v[40:41], v8, s[32:35], s52 offen sc1
    s_mov_b64 exec, -1
L_G3skipx1:
    s_barrier
    s_barrier
    s_add_u32 s60, s87, s81
    s_add_u32 s60, s60, 0xf0000
    s_sleep 20
    s_mov_b32 s80, 0
Lpoll_13:
    buffer_load_dwordx4 v[64:67], v4, s[32:35], s60 offen offset:0 sc1
    buffer_load_dwordx4 v[68:71], v4, s[32:35], s60 offen offset:1024 sc1
    buffer_load_dwordx4 v[72:75], v4, s[32:35], s60 offen offset:2048 sc1
    buffer_load_dwordx4 v[76:79], v10, s[32:35], s60 offen offset:3072 sc1
    s_waitcnt vmcnt(0)
    v_max3_u32 v40, v64, v65, v66
    v_max3_u32 v40, v40, v67, v68
    v_max3_u32 v40, v40, v69, v70
    v_max3_u32 v40, v40, v71, v72
    v_max3_u32 v40, v40, v73, v74
    v_max3_u32 v40, v40, v75, v76
    v_max3_u32 v40, v40, v77, v78
    v_max_u32 v40, v40, v79
    v_cmp_eq_u32 vcc, -1, v40
    s_add_u32 s80, s80, 1
    s_cbranch_vccz Lpolld_14
    s_sleep 1
    s_cmp_lt_u32 s80, 0x100000
    s_cbranch_scc1 Lpoll_13
Lpolld_14:
    v_pk_mul_f32 v[76:77], v[76:77], v[12:13] op_sel_hi:[1,0]
    v_pk_mul_f32 v[78:79], v[78:79], v[12:13] op_sel_hi:[1,0]
    v_pk_add_f32 v[64:65], v[64:65], v[68:69]
    v_pk_add_f32 v[72:73], v[72:73], v[76:77]
    v_pk_add_f32 v[66:67], v[66:67], v[70:71]
    v_pk_add_f32 v[74:75], v[74:75], v[78:79]
    v_pk_add_f32 v[64:65], v[64:65], v[72:73]
    v_pk_add_f32 v[66:67], v[66:67], v[74:75]
    s_add_u32 s52, s92, s81
    s_add_u32 s52, s52, 0x161400
    v_add_f32_dpp v64, v64, v64 row_ror:8 row_mask:0xf bank_mask:0xf
    v_add_f32_dpp v65, v65, v65 row_ror:8 row_mask:0xf bank_mask:0xf
    v_add_f32_dpp v66, v66, v66 row_ror:8 row_mask:0xf bank_mask:0xf
    v_add_f32_dpp v67, v67, v67 row_ror:8 row_mask:0xf bank_mask:0xf
    v_add_f32_dpp v64, v64, v64 row_ror:4 row_mask:0xf bank_mask:0xf
    v_add_f32_dpp v65, v65, v65 row_ror:4 row_mask:0xf bank_mask:0xf
    v_add_f32_dpp v66, v66, v66 row_ror:4 row_mask:0xf bank_mask:0xf
    v_add_f32_dpp v67, v67, v67 row_ror:4 row_mask:0xf bank_mask:0xf
    v_add_f32_dpp v64, v64, v64 row_ror:2 row_mask:0xf bank_mask:0xf
    v_add_f32_dpp v65, v65, v65 row_ror:2 row_mask:0xf bank_mask:0xf
    v_add_f32_dpp v66, v66, v66 row_ror:2 row_mask:0xf bank_mask:0xf
    v_add_f32_dpp v67, v67, v67 row_ror:2 row_mask:0xf bank_mask:0xf
    v_add_f32_dpp v64, v64, v64 row_ror:1 row_mask:0xf bank_mask:0xf
    v_add_f32_dpp v65, v65, v65 row_ror:1 row_mask:0xf bank_mask:0xf
    v_add_f32_dpp v66, v66, v66 row_ror:1 row_mask:0xf bank_mask:0xf
    v_add_f32_dpp v67, v67, v67 row_ror:1 row_mask:0xf bank_mask:0xf
    v_add_f32_dpp v64, v64, v64 row_bcast:15 row_mask:0xa bank_mask:0xf
    v_add_f32_dpp v65, v65, v65 row_bcast:15 row_mask:0xa bank_mask:0xf
    v_add_f32_dpp v66, v66, v66 row_bcast:15 row_mask:0xa bank_mask:0xf
    v_add_f32_dpp v67, v67, v67 row_bcast:15 row_mask:0xa bank_mask:0xf
    v_add_f32_dpp v64, v64, v64 row_bcast:31 row_mask:0xc bank_mask:0xf
    v_add_f32_dpp v65, v65, v65 row_bcast:31 row_mask:0xc bank_mask:0xf
    v_add_f32_dpp v66, v66, v66 row_bcast:31 row_mask:0xc bank_mask:0xf
    v_add_f32_dpp v67, v67, v67 row_bcast:31 row_mask:0xc bank_mask:0xf
    v_cvt_pk_bf16_f32 v40, v64, v65
    v_cvt_pk_bf16_f32 v41, v66, v67
    v_lshlrev_b32 v64, 16, v40
    v_and_b32 v65, 0xffff0000, v40
    v_lshlrev_b32 v66, 16, v41
    v_and_b32 v67, 0xffff0000, v41
    v_pk_add_f32 v[64:65], v[64:65], v[20:21]
    v_pk_add_f32 v[66:67], v[66:67], v[22:23]
    v_cvt_pk_bf16_f32 v40, v64, v65
    v_cvt_pk_bf16_f32 v41, v66, v67
    v_lshlrev_b32 v64, 16, v40
    v_and_b32 v65, 0xffff0000, v40
    v_lshlrev_b32 v66, 16, v41
    v_and_b32 v67, 0xffff0000, v41
    v_pk_add_f32 v[16:17], v[16:17], v[64:65]
    v_pk_add_f32 v[18:19], v[18:19], v[66:67]
    v_cvt_pk_bf16_f32 v40, v16, v17
    v_cvt_pk_bf16_f32 v41, v18, v19
    v_lshlrev_b32 v16, 16, v40
    v_and_b32 v17, 0xffff0000, v40
    v_lshlrev_b32 v18, 16, v41
    v_and_b32 v19, 0xffff0000, v41
    s_cmp_lg_u32 s81, 0x8000
    s_cbranch_scc1 L_G3final
    s_cmp_ge_u32 s3, 14
    s_cbranch_scc1 L_G3skipx2
    s_mov_b32 exec_lo, 0
    s_mov_b32 exec_hi, 0x80000000
    buffer_store_dwordx2 v[40:41], v8, s[32:35], s52 offen sc1
    s_mov_b64 exec, -1
L_G3skipx2:
    s_barrier
    s_barrier
    s_barrier
    s_barrier
    s_add_u32 s81, s81, 0x164000
    s_branch L_G3loop
L_G3final:
    s_cmp_ge_u32 s3, 14
    s_cbranch_scc1 L_G3skipout
    s_mov_b32 exec_lo, 0
    s_mov_b32 exec_hi, 0x80000000
    buffer_store_dwordx2 v[40:41], v8, s[36:39], s92 offen
    s_mov_b64 exec, -1
L_G3skipout:
    s_cmp_lg_u32 s2, 0
    s_cbranch_scc1 L_G3skipep
    s_mov_b32 s52, 0x4000
    v_mov_b32 v40, s94
    s_mov_b32 exec_lo, 0x1
    s_mov_b32 exec_hi, 0
    buffer_store_dword v40, v8, s[32:35], s52 offen sc1
    s_mov_b64 exec, -1
L_G3skipep:
L_end:
    s_endpgm
.section .rodata,"a"
.p2align 6
.amdhsa_kernel interleave_layers__sliding_block_cached__mixer_channel_mlp__decode_kernel
  .amdhsa_next_free_vgpr 256
  .amdhsa_next_free_sgpr 102
  .amdhsa_accum_offset 256
  .amdhsa_group_segment_fixed_size 0
  .amdhsa_kernarg_size 104
  .amdhsa_user_sgpr_count 2
  .amdhsa_user_sgpr_kernarg_segment_ptr 1
  .amdhsa_system_sgpr_workgroup_id_x 1
.end_amdhsa_kernel
```
